```python
import torch

def _softmax(x, axis=-1):
    return torch.softmax(x, dim=axis)

def _gelu(x):
    return torch.nn.functional.gelu(x, approximate='tanh')

def _silu(x):
    return torch.nn.functional.silu(x)

def _sigmoid(x):
    return torch.sigmoid(x)

def _layernorm(x, axis=-1, eps=1e-05):
    m = x.mean(dim=axis, keepdim=True)
    v = x.var(dim=axis, keepdim=True, unbiased=False)
    return (x - m) / torch.sqrt(v + eps)

def _scatter_add(tgt, idx, src, axis=0):
    return tgt.clone().index_add_(axis, idx, src)

def _segment_sum(src, seg, n):
    out = torch.zeros((n,) + src.shape[1:], dtype=src.dtype)
    return out.index_add_(0, seg, src)

def _pad(x, pw):
    flat = tuple((v for pair in reversed(pw) for v in pair))
    return torch.nn.functional.pad(x, flat)
kernel_name = 'adaLN_cond__ssm_conv_h3__swiglu_ffn__prompt'

def setup_inputs():

    _w = lambda a: (lambda t: t.to(torch.bfloat16) if t.is_floating_point() else t)(torch.as_tensor(a))

    def _A_setup():
        B, S, D = (1, 2048, 512)
        ks = 4
        return {'q': _w((lambda *s: torch.randn(*s, dtype=torch.bfloat16) * 0.05)(B, S, D)), 'k': _w((lambda *s: torch.randn(*s, dtype=torch.bfloat16) * 0.8)(B, S, D)), 'v': _w((lambda *s: torch.randn(*s, dtype=torch.bfloat16) * 0.8)(B, S, D)), 'shift_k': _w((lambda *s: torch.randn(*s, dtype=torch.bfloat16) * 0.8)(D, ks) * 0.5), 'ssm_k': _w((lambda *s: torch.randn(*s, dtype=torch.bfloat16) * 0.8)(D, S) * (1.0 / S ** 0.5)), 'ssm_D': _w((lambda *s: torch.randn(*s, dtype=torch.bfloat16) * 0.8)(D))}
    _A_in = _A_setup()

    def _B_setup():
        B, S, D, F = (1, 2048, 512, 1792)
        return {'x': _w((lambda *s: torch.randn(*s, dtype=torch.bfloat16) * 0.05)(B, S, D)), 'w_gate': _w((lambda *s: torch.randn(*s, dtype=torch.bfloat16) * 0.05)(D, F)), 'w_up': _w((lambda *s: torch.randn(*s, dtype=torch.bfloat16) * 0.05)(D, F)), 'w_down': _w((lambda *s: torch.randn(*s, dtype=torch.bfloat16) * 0.05)(F, D))}
    _B_in = _B_setup()
    return {'A_q': _A_in['q'], 'A_k': _A_in['k'], 'A_v': _A_in['v'], 'A_shift_k': _A_in['shift_k'], 'A_ssm_k': _A_in['ssm_k'], 'A_ssm_D': _A_in['ssm_D'], 'B_x': _B_in['x'], 'B_w_gate': _B_in['w_gate'], 'B_w_up': _B_in['w_up'], 'B_w_down': _B_in['w_down'], 'c': _w((lambda *s: torch.randn(*s, dtype=torch.bfloat16) * 0.1)(1, 512) * 8.0), 'w_mod': _w((lambda *s: torch.randn(*s, dtype=torch.bfloat16) * 0.1)(512, 6 * 512) * 512 ** (-0.5) * 8.0)}

def reference(A_q, A_k, A_v, A_shift_k, A_ssm_k, A_ssm_D, B_x, B_w_gate, B_w_up, B_w_down, c, w_mod):

    def _A_ref(q, k, v, shift_k, ssm_k, ssm_D):
        B, S, D = q.shape
        ks = shift_k.shape[-1]
        k_pad = _pad(k, ((0, 0), (ks - 1, 0), (0, 0)))
        k_shift = torch.zeros_like(k)
        for t in range(ks):
            k_shift = k_shift + k_pad[:, t:t + S, :] * shift_k[:, ks - 1 - t][None, None, :]
        kv = k_shift * v
        L = 2 * S
        kv_pad = _pad(kv, ((0, 0), (0, S), (0, 0)))
        kf_pad = _pad(ssm_k, ((0, 0), (0, S)))
        kv_f = (lambda x, axes=(-2, -1): torch.fft.rfft2(x.float(), dim=axes))(kv_pad[:, None, :, :], axes=(1, 2))
        kf_f = (lambda x, axes=(-2, -1): torch.fft.rfft2(x.float(), dim=axes))(kf_pad[:, None, :], axes=(1, 2))
        kf_f = (lambda x, *d: x.permute(*d))(kf_f, 1, 2, 0)
        y_f = kv_f * kf_f[None, :, :, :]
        y = (lambda x, s, axes=(-2, -1): torch.fft.irfft2(x, s=s, dim=axes).to(torch.bfloat16))(y_f, (1, L), axes=(1, 2))[:, 0, :S, :]
        y = y + kv * ssm_D[None, None, :]
        return q * y

    def _B_ref(x, w_gate, w_up, w_down):
        g = _silu(x @ w_gate)
        u = x @ w_up
        return g * u @ w_down
    x = A_q
    mod = (_silu(c) @ w_mod).reshape(c.shape[0], 6, 1, -1)
    sa, ca, ga, sb, cb, gb = (mod[:, 0].clone(), mod[:, 1].clone(), mod[:, 2].clone(), mod[:, 3].clone(), mod[:, 4].clone(), mod[:, 5].clone())
    h = _layernorm(x, axis=-1) * (1 + ca) + sa
    x = x + ga * _A_ref(h, A_k, A_v, A_shift_k, A_ssm_k, A_ssm_D)
    h = _layernorm(x, axis=-1) * (1 + cb) + sb
    x = x + gb * _B_ref(h, B_w_gate, B_w_up, B_w_down)
    return x
```

```asm
; @launch kernel=conv_kernel grid=(256,1,1) block=(512,1,1) lds=108544
; @launch kernel=ffn_kernel grid=(256,1,1) block=(512,1,1) lds=163840
.amdgcn_target "amdgcn-amd-amdhsa--gfx950"
.text
.globl conv_kernel
.p2align 8
.type conv_kernel,@function
conv_kernel:
  s_cmp_ge_u32 s2, 256
  s_cbranch_scc1 conv_kernel_end
  s_load_dwordx2 s[8:9], s[0:1], 8
  s_load_dwordx2 s[12:13], s[0:1], 16
  s_load_dwordx2 s[16:17], s[0:1], 24
  s_load_dwordx2 s[20:21], s[0:1], 0
  s_load_dwordx2 s[24:25], s[0:1], 32
  s_load_dwordx2 s[28:29], s[0:1], 112
  s_load_dwordx2 s[32:33], s[0:1], 88
  s_load_dwordx2 s[36:37], s[0:1], 104
  s_load_dwordx2 s[48:49], s[0:1], 40
  s_load_dwordx2 s[50:51], s[0:1], 80
  s_mov_b32 s10, 0x200000
  s_mov_b32 s11, 0x20000
  s_mov_b32 s14, 0x200000
  s_mov_b32 s15, 0x20000
  s_mov_b32 s18, 0x1000
  s_mov_b32 s19, 0x20000
  s_mov_b32 s22, 0x200000
  s_mov_b32 s23, 0x20000
  s_mov_b32 s26, 0x200000
  s_mov_b32 s27, 0x20000
  s_mov_b32 s30, 0x1300000
  s_mov_b32 s31, 0x20000
  s_mov_b32 s34, 0x300000
  s_mov_b32 s35, 0x20000
  s_mov_b32 s38, 0x100
  s_mov_b32 s39, 0x20000
  s_lshr_b32 s4, s2, 3
  s_and_b32 s5, s2, 7
  v_lshrrev_b32 v4, 6, v0
  v_and_b32 v1, 63, v0
  v_readfirstlane_b32 s6, v4
  v_and_b32 v2, 15, v0
  v_lshrrev_b32 v3, 4, v0
  v_lshlrev_b32 v12, 4, v0
  s_lshl_b32 s44, s4, 16
  s_lshl_b32 s45, s5, 7
  s_add_u32 s44, s44, s45
  v_lshlrev_b32 v6, 11, v3
  v_lshl_add_u32 v6, v2, 3, v6
  v_add_u32 v6, s44, v6
  v_add_u32 v14, 0xfffff400, v6
  v_add_u32 v15, 0xfffff800, v6
  v_add_u32 v16, 0xfffffc00, v6
  s_lshl_b32 s45, s5, 9
  v_lshl_add_u32 v10, v2, 5, s45
  s_lshl_b32 s46, s2, 3
  s_add_u32 s46, s46, s6
  s_lshl_b32 s46, s46, 10
  v_lshlrev_b32 v11, 4, v1
  s_lshl_b32 s7, s5, 5
  s_add_u32 s7, s7, s4
  s_lshr_b32 s3, s6, 2
  s_and_b32 s100, s6, 3
  v_lshrrev_b32 v4, 3, v1
  s_lshl_b32 s44, s4, 5
  v_lshl_add_u32 v5, v4, 2, s44
  v_mul_u32_u24 v49, 12288, v4
  v_and_b32 v4, 7, v1
  v_lshl_add_u32 v49, v4, 4, v49
  s_mul_i32 s44, s4, 98304
  s_lshl_b32 s45, s5, 7
  s_add_u32 s44, s44, s45
  s_lshl_b32 s45, s6, 10
  s_add_u32 s44, s44, s45
  s_cmp_lt_u32 s6, 6
  s_cselect_b32 s44, s44, 0x40000000
  s_add_u32 s45, s44, 6144
  s_waitcnt lgkmcnt(0)
  s_cmp_lg_u32 s2, 0
  s_cbranch_scc1 conv_kernel_nozs
  v_mov_b32 v108, 0
  v_mov_b32 v109, 0
  v_mov_b32 v110, 0
  v_mov_b32 v111, 0
  s_mov_b32 s47, 17039360
  buffer_store_dwordx4 v[108:111], v12, s[28:31], s47 offen sc1
  s_mov_b32 s47, 17104896
  buffer_store_dwordx4 v[108:111], v12, s[28:31], s47 offen sc1
  s_mov_b32 s47, 17113088
  buffer_store_dwordx4 v[108:111], v12, s[28:31], s47 offen sc1
conv_kernel_nozs:
  buffer_load_dwordx2 v[18:19], v14, s[8:11], 0 offen
  buffer_load_dwordx2 v[20:21], v15, s[8:11], 0 offen
  buffer_load_dwordx2 v[22:23], v16, s[8:11], 0 offen
  buffer_load_dwordx2 v[24:25], v6, s[8:11], 0 offen offset:0
  buffer_load_dwordx2 v[26:27], v6, s[8:11], 0 offen offset:1024
  buffer_load_dwordx2 v[28:29], v6, s[12:15], 0 offen offset:0
  buffer_load_dwordx2 v[30:31], v6, s[12:15], 0 offen offset:1024
  buffer_load_dwordx4 v[32:35], v10, s[16:19], 0 offen offset:0
  buffer_load_dwordx4 v[36:39], v10, s[16:19], 0 offen offset:16
  s_barrier
  buffer_load_dwordx2 v[40:41], v6, s[20:23], 0 offen offset:0
  buffer_load_dwordx2 v[42:43], v6, s[20:23], 0 offen offset:1024
  buffer_load_dwordx4 v[44:47], v11, s[20:23], s46 offen
  s_mov_b32 s16, s50
  s_mov_b32 s17, s51
  s_movk_i32 s18, 1024
  buffer_load_dword v48, v5, s[16:19], 0 offen
  buffer_load_dwordx4 v[52:55], v49, s[32:35], s44 offen
  buffer_load_dwordx4 v[56:59], v49, s[32:35], s45 offen
  s_cmp_lg_u32 s2, 0
  s_cbranch_scc1 conv_kernel_nozero
  s_waitcnt vmcnt(15)
  s_barrier
  s_cmp_lg_u32 s6, 0
  s_cbranch_scc1 conv_kernel_nozero
  v_mov_b32 v4, 0
  v_mov_b32 v5, 1
  s_mov_b64 exec, 1
  buffer_store_dword v5, v4, s[36:39], 0 offen sc1
  s_mov_b64 exec, -1
conv_kernel_nozero:
  s_lshl_b32 s44, s7, 2
  s_load_dword s101, s[48:49], s44
  s_load_dwordx4 s[52:55], s[0:1], 56
  s_load_dwordx2 s[56:57], s[0:1], 72
  v_sub_u32 v4, 31, v3
  v_lshrrev_b32 v7, 2, v4
  v_and_b32 v5, 7, v2
  v_xor_b32 v7, v7, v5
  v_lshlrev_b32 v7, 4, v7
  v_and_b32 v4, 3, v4
  v_lshl_add_u32 v7, v4, 2, v7
  v_lshl_add_u32 v7, v2, 9, v7
  v_add_u32 v7, 43008, v7
  v_lshrrev_b32 v4, 3, v0
  v_and_b32 v5, 7, v0
  v_bfe_u32 v8, v0, 5, 3
  v_xor_b32 v8, v8, v5
  v_lshlrev_b32 v8, 4, v8
  v_lshl_add_u32 v8, v4, 7, v8
  v_add_u32 v8, 43008, v8
  s_lshl_b32 s44, s5, 18
  s_lshl_b32 s45, s4, 7
  s_sub_u32 s44, s44, s45
  s_add_u32 s44, s44, 3968
  v_lshlrev_b32 v9, 12, v4
  v_lshl_add_u32 v9, v5, 4, v9
  v_add_u32 v9, s44, v9
  v_mul_u32_u24 v10, 288, v3
  v_lshl_add_u32 v10, v2, 3, v10
  v_add_u32 v10, 51200, v10
  s_waitcnt vmcnt(6)
  v_lshlrev_b32 v92, 16, v32
  v_and_b32 v96, 0xffff0000, v32
  v_lshlrev_b32 v100, 16, v33
  v_and_b32 v104, 0xffff0000, v33
  v_lshlrev_b32 v93, 16, v34
  v_and_b32 v97, 0xffff0000, v34
  v_lshlrev_b32 v101, 16, v35
  v_and_b32 v105, 0xffff0000, v35
  v_lshlrev_b32 v94, 16, v36
  v_and_b32 v98, 0xffff0000, v36
  v_lshlrev_b32 v102, 16, v37
  v_and_b32 v106, 0xffff0000, v37
  v_lshlrev_b32 v95, 16, v38
  v_and_b32 v99, 0xffff0000, v38
  v_lshlrev_b32 v103, 16, v39
  v_and_b32 v107, 0xffff0000, v39
  v_lshlrev_b32 v72, 16, v18
  v_and_b32 v73, 0xffff0000, v18
  v_lshlrev_b32 v74, 16, v19
  v_and_b32 v75, 0xffff0000, v19
  v_lshlrev_b32 v76, 16, v20
  v_and_b32 v77, 0xffff0000, v20
  v_lshlrev_b32 v78, 16, v21
  v_and_b32 v79, 0xffff0000, v21
  v_lshlrev_b32 v80, 16, v22
  v_and_b32 v81, 0xffff0000, v22
  v_lshlrev_b32 v82, 16, v23
  v_and_b32 v83, 0xffff0000, v23
  v_lshlrev_b32 v84, 16, v24
  v_and_b32 v85, 0xffff0000, v24
  v_lshlrev_b32 v86, 16, v25
  v_and_b32 v87, 0xffff0000, v25
  v_lshlrev_b32 v88, 16, v26
  v_and_b32 v89, 0xffff0000, v26
  v_lshlrev_b32 v90, 16, v27
  v_and_b32 v91, 0xffff0000, v27
  v_pk_mul_f32 v[108:109], v[84:85], v[92:93]
  v_pk_mul_f32 v[110:111], v[86:87], v[94:95]
  v_pk_mul_f32 v[112:113], v[88:89], v[92:93]
  v_pk_mul_f32 v[114:115], v[90:91], v[94:95]
  v_pk_fma_f32 v[108:109], v[80:81], v[96:97], v[108:109]
  v_pk_fma_f32 v[110:111], v[82:83], v[98:99], v[110:111]
  v_pk_fma_f32 v[112:113], v[84:85], v[96:97], v[112:113]
  v_pk_fma_f32 v[114:115], v[86:87], v[98:99], v[114:115]
  v_pk_fma_f32 v[108:109], v[76:77], v[100:101], v[108:109]
  v_pk_fma_f32 v[110:111], v[78:79], v[102:103], v[110:111]
  v_pk_fma_f32 v[112:113], v[80:81], v[100:101], v[112:113]
  v_pk_fma_f32 v[114:115], v[82:83], v[102:103], v[114:115]
  v_pk_fma_f32 v[108:109], v[72:73], v[104:105], v[108:109]
  v_pk_fma_f32 v[110:111], v[74:75], v[106:107], v[110:111]
  v_pk_fma_f32 v[112:113], v[76:77], v[104:105], v[112:113]
  v_pk_fma_f32 v[114:115], v[78:79], v[106:107], v[114:115]
  v_lshlrev_b32 v72, 16, v28
  v_and_b32 v73, 0xffff0000, v28
  v_lshlrev_b32 v74, 16, v29
  v_and_b32 v75, 0xffff0000, v29
  v_lshlrev_b32 v76, 16, v30
  v_and_b32 v77, 0xffff0000, v30
  v_lshlrev_b32 v78, 16, v31
  v_and_b32 v79, 0xffff0000, v31
  v_pk_mul_f32 v[108:109], v[108:109], v[72:73]
  v_pk_mul_f32 v[110:111], v[110:111], v[74:75]
  v_pk_mul_f32 v[112:113], v[112:113], v[76:77]
  v_pk_mul_f32 v[114:115], v[114:115], v[78:79]
  v_cvt_pk_bf16_f32 v80, v112, v108
  v_cvt_pk_bf16_f32 v81, v113, v109
  v_cvt_pk_bf16_f32 v82, v114, v110
  v_cvt_pk_bf16_f32 v83, v115, v111
  ds_write_b32 v7, v80 offset:0
  ds_write_b32 v7, v81 offset:128
  ds_write_b32 v7, v82 offset:256
  ds_write_b32 v7, v83 offset:384
  s_waitcnt lgkmcnt(0)
  s_barrier
  ds_read_b128 v[108:111], v8
  v_and_b32 v2, 15, v0
  v_lshrrev_b32 v3, 4, v0
  v_mul_u32_u24 v4, 144, v2
  v_lshl_add_u32 v4, v3, 2, v4
  v_add_u32 v8, 51200, v4
  s_waitcnt lgkmcnt(0)
  buffer_store_dwordx4 v[108:111], v9, s[28:31], 0 offen sc1
  v_and_b32 v4, 255, v0
  v_lshlrev_b32 v12, 4, v4
  s_lshl_b32 s44, s7, 13
  s_lshl_b32 s45, s3, 12
  s_add_u32 s44, s44, s45
  buffer_load_dwordx4 v[60:63], v12, s[24:27], s44 offen offset:0
  buffer_load_dwordx4 v[64:67], v12, s[24:27], s44 offen offset:4
  buffer_load_dwordx4 v[68:71], v12, s[24:27], s44 offen offset:8
  s_waitcnt vmcnt(8)
  ds_write_b64 v10, v[40:41] offset:0
  ds_write_b64 v10, v[42:43] offset:144
  s_lshl_b32 s44, s5, 18
  s_lshl_b32 s45, s4, 8
  s_add_u32 s44, s44, s45
  s_add_u32 s47, s44, 17825792
  v_lshlrev_b32 v9, 13, v3
  v_lshl_add_u32 v9, v2, 4, v9
  s_waitcnt lgkmcnt(0)
  s_barrier
  ds_read_b32 v112, v8 offset:0
  ds_read_b32 v113, v8 offset:2304
  ds_read_b32 v114, v8 offset:4608
  ds_read_b32 v115, v8 offset:6912
  s_waitcnt vmcnt(7)
  v_lshlrev_b32 v72, 16, v44
  v_and_b32 v73, 0xffff0000, v44
  v_lshlrev_b32 v74, 16, v45
  v_and_b32 v75, 0xffff0000, v45
  v_lshlrev_b32 v76, 16, v46
  v_and_b32 v77, 0xffff0000, v46
  v_lshlrev_b32 v78, 16, v47
  v_and_b32 v79, 0xffff0000, v47
  v_pk_add_f32 v[80:81], v[72:73], v[74:75]
  v_pk_mul_f32 v[82:83], v[72:73], v[72:73]
  v_pk_add_f32 v[72:73], v[76:77], v[78:79]
  v_pk_fma_f32 v[82:83], v[74:75], v[74:75], v[82:83]
  v_pk_fma_f32 v[82:83], v[76:77], v[76:77], v[82:83]
  v_pk_fma_f32 v[82:83], v[78:79], v[78:79], v[82:83]
  v_pk_add_f32 v[80:81], v[80:81], v[72:73]
  v_add_f32 v82, v82, v83
  v_add_f32 v80, v80, v81
  s_waitcnt lgkmcnt(0)
  buffer_store_dwordx4 v[112:115], v9, s[28:31], s47 offen sc1
  s_waitcnt vmcnt(5)
  v_lshlrev_b32 v92, 16, v48
  v_and_b32 v93, 0xffff0000, v48
  s_mov_b32 s44, 0xbfb8aa3b
  v_add_f32_dpp v80, v80, v80 row_ror:8 row_mask:0xf bank_mask:0xf
  v_add_f32_dpp v82, v82, v82 row_ror:8 row_mask:0xf bank_mask:0xf
  v_mul_f32 v94, s44, v92
  v_mul_f32 v95, s44, v93
  v_add_f32_dpp v80, v80, v80 row_ror:4 row_mask:0xf bank_mask:0xf
  v_add_f32_dpp v82, v82, v82 row_ror:4 row_mask:0xf bank_mask:0xf
  v_exp_f32 v94, v94
  v_exp_f32 v95, v95
  v_add_f32_dpp v80, v80, v80 row_ror:2 row_mask:0xf bank_mask:0xf
  v_add_f32_dpp v82, v82, v82 row_ror:2 row_mask:0xf bank_mask:0xf
  v_add_f32 v94, 1.0, v94
  v_add_f32 v95, 1.0, v95
  v_add_f32_dpp v80, v80, v80 row_ror:1 row_mask:0xf bank_mask:0xf
  v_add_f32_dpp v82, v82, v82 row_ror:1 row_mask:0xf bank_mask:0xf
  v_rcp_f32 v94, v94
  v_rcp_f32 v95, v95
  v_add_f32_dpp v80, v80, v80 row_bcast:15 row_mask:0xa bank_mask:0xf
  v_add_f32_dpp v82, v82, v82 row_bcast:15 row_mask:0xa bank_mask:0xf
  v_mul_f32 v92, v92, v94
  v_mul_f32 v93, v93, v95
  v_add_f32_dpp v80, v80, v80 row_bcast:31 row_mask:0xc bank_mask:0xf
  v_add_f32_dpp v82, v82, v82 row_bcast:31 row_mask:0xc bank_mask:0xf
  v_cvt_pk_bf16_f32 v48, v92, v93
  s_mov_b32 s44, 0x05040100
  s_mov_b32 s45, 0x07060302
  v_perm_b32 v92, v56, v52, s44
  v_perm_b32 v93, v56, v52, s45
  v_perm_b32 v94, v57, v53, s44
  v_perm_b32 v95, v57, v53, s45
  v_perm_b32 v96, v58, v54, s44
  v_perm_b32 v97, v58, v54, s45
  v_perm_b32 v98, v59, v55, s44
  v_perm_b32 v99, v59, v55, s45
  s_mov_b32 s44, 0x3b000000
  v_mul_f32 v80, s44, v80
  v_mul_f32 v82, s44, v82
  v_dot2_f32_bf16 v116, v92, v48, 0
  v_dot2_f32_bf16 v117, v93, v48, 0
  v_dot2_f32_bf16 v118, v94, v48, 0
  v_dot2_f32_bf16 v119, v95, v48, 0
  v_dot2_f32_bf16 v120, v96, v48, 0
  v_dot2_f32_bf16 v121, v97, v48, 0
  v_dot2_f32_bf16 v122, v98, v48, 0
  v_dot2_f32_bf16 v123, v99, v48, 0
  v_fma_f32 v82, -v80, v80, v82
  s_mov_b32 s44, 0x3727c5ac
  v_max_f32 v82, 0, v82
  v_add_f32 v82, s44, v82
  v_rsq_f32 v82, v82
  v_permlane32_swap_b32 v116, v120
  v_permlane32_swap_b32 v117, v121
  v_permlane32_swap_b32 v118, v122
  v_permlane32_swap_b32 v119, v123
  v_mov_b32 v83, v80
  v_add_f32 v116, v116, v120
  v_add_f32 v117, v117, v121
  v_add_f32 v118, v118, v122
  v_add_f32 v119, v119, v123
  s_lshl_b32 s44, s6, 3
  s_add_u32 s44, s44, 60416
  v_mov_b32 v4, s44
  v_permlane16_swap_b32 v116, v118
  v_permlane16_swap_b32 v117, v119
  s_mov_b32 s46, 0
  s_brev_b32 s47, 1
  v_add_f32 v116, v116, v118
  v_add_f32 v117, v117, v119
  s_mov_b64 exec, s[46:47]
  ds_write_b64 v4, v[82:83]
  s_mov_b64 exec, -1
  v_add_f32_dpp v116, v116, v116 row_ror:8 row_mask:0xf bank_mask:0xf
  v_add_f32_dpp v117, v117, v117 row_ror:8 row_mask:0xf bank_mask:0xf
  v_and_b32 v49, 7, v1
  v_lshlrev_b32 v49, 5, v49
  v_lshrrev_b32 v4, 4, v1
  v_lshl_add_u32 v49, v4, 3, v49
  v_and_b32 v4, 8, v1
  v_lshl_or_b32 v49, v4, 27, v49
  s_mul_i32 s44, s7, 1536
  s_lshl_b32 s45, s6, 8
  s_add_u32 s44, s44, s45
  s_add_u32 s44, s44, 17301504
  s_cmp_lt_u32 s6, 6
  s_cselect_b32 s44, s44, 0x20000000
  buffer_store_dwordx2 v[116:117], v49, s[28:31], s44 offen sc1
  s_cmp_eq_u32 s6, 0
  s_cselect_b32 s44, 0, 0x400
  v_mov_b32 v4, s44
  buffer_load_dword v13, v4, s[36:39], 0 offen sc1
  s_waitcnt vmcnt(0) lgkmcnt(0)
  s_barrier
  s_cmp_lg_u32 s6, 0
  s_cbranch_scc1 conv_kernel_arr1
  v_readfirstlane_b32 s44, v13
  s_mov_b32 s45, 200000
conv_kernel_rdy:
  s_cmp_lg_u32 s44, 0
  s_cbranch_scc1 conv_kernel_rdyok
  v_mov_b32 v4, 0
  buffer_load_dword v13, v4, s[36:39], 0 offen sc1
  s_waitcnt vmcnt(0)
  v_readfirstlane_b32 s44, v13
  s_sub_u32 s45, s45, 1
  s_cmp_lg_u32 s45, 0
  s_cbranch_scc1 conv_kernel_rdy
conv_kernel_rdyok:
  s_lshl_b32 s44, s5, 8
  s_add_u32 s44, s44, 17043456
  v_mov_b32 v4, s44
  v_mov_b32 v5, 1
  s_mov_b64 exec, 1
  buffer_atomic_add v5, v4, s[28:31], 0 offen sc1
  s_mov_b64 exec, -1
  v_lshlrev_b32 v4, 4, v1
  ds_read_b128 v[108:111], v4 offset:60416
  s_lshl_b32 s44, s2, 6
  s_add_u32 s44, s44, 17104896
  s_waitcnt lgkmcnt(0)
  s_mov_b64 exec, 0xf
  buffer_store_dwordx4 v[108:111], v4, s[28:31], s44 offen sc1
  s_mov_b64 exec, -1
conv_kernel_arr1:
  v_alignbit_b32 v92, v64, v60, 16
  v_alignbit_b32 v93, v65, v61, 16
  v_alignbit_b32 v94, v66, v62, 16
  v_alignbit_b32 v95, v67, v63, 16
  v_alignbit_b32 v96, v68, v64, 16
  v_alignbit_b32 v97, v69, v65, 16
  v_alignbit_b32 v98, v70, v66, 16
  v_alignbit_b32 v99, v71, v67, 16
  s_mul_i32 s44, s3, 16640
  s_add_u32 s44, s44, 9248
  v_add_u32 v104, s44, v12
  v_mov_b32 v100, 0
  v_mov_b32 v101, 0
  v_mov_b32 v102, 0
  v_mov_b32 v103, 0
  ds_write_b128 v104, v[60:63]
  ds_write_b128 v104, v[64:67] offset:8320
  ds_write_b128 v104, v[92:95] offset:4160
  ds_write_b128 v104, v[96:99] offset:12480
  s_cmp_lg_u32 s6, 1
  s_cbranch_scc1 conv_kernel_nozt
  v_lshrrev_b32 v3, 5, v1
  v_mul_u32_u24 v3, 4608, v3
  v_and_b32 v4, 31, v1
  v_lshl_add_u32 v3, v4, 4, v3
  ds_write_b128 v3, v[100:103] offset:4096
conv_kernel_nozt:
  s_cmp_lg_u32 s100, 0
  s_cbranch_scc1 conv_kernel_noneg
  s_mov_b64 exec, 1
  v_subrev_u32 v2, 32, v104
  v_mov_b32 v72, 0
  v_mov_b32 v73, 0
  v_mov_b32 v74, 0
  v_mov_b32 v75, 0
  v_mov_b32 v76, 0
  v_mov_b32 v77, 0
  v_mov_b32 v78, 0
  v_mov_b32 v79, 0
  v_mov_b32 v80, 0
  v_mov_b32 v81, 0
  v_mov_b32 v82, 0
  v_mov_b32 v83, 0
  ds_write_b128 v2, v[100:103] offset:0
  ds_write_b128 v2, v[100:103] offset:4160
  ds_write_b128 v2, v[100:103] offset:8320
  ds_write_b128 v2, v[100:103] offset:12480
  ds_write_b128 v2, v[100:103] offset:16
  v_lshlrev_b32 v75, 16, v60
  v_mov_b32 v79, v60
  v_lshlrev_b32 v82, 16, v60
  v_alignbit_b32 v83, v61, v60, 16
  ds_write_b128 v2, v[72:75] offset:4176
  ds_write_b128 v2, v[76:79] offset:8336
  ds_write_b128 v2, v[80:83] offset:12496
  s_mov_b64 exec, -1
conv_kernel_noneg:
  s_bfe_u32 s61, s6, 0x10001
  s_and_b32 s62, s6, 1
  v_and_b32 v2, 15, v1
  v_lshrrev_b32 v3, 4, v1
  v_lshlrev_b32 v4, 5, v2
  v_sub_u32 v4, 480, v4
  v_lshl_add_u32 v4, v3, 4, v4
  s_mul_i32 s44, s61, 4608
  s_lshl_b32 s45, s62, 8
  s_add_u32 s44, s44, s45
  v_add_u32 v208, s44, v4
  v_add_u32 v4, 1, v2
  v_and_b32 v5, 3, v4
  v_sub_u32 v4, v4, v5
  v_lshl_add_u32 v4, v3, 3, v4
  v_lshlrev_b32 v4, 1, v4
  v_mul_u32_u24 v5, 4160, v5
  s_mul_i32 s44, s61, 16640
  s_add_u32 s44, s44, s45
  s_add_u32 s44, s44, 9216
  v_add3_u32 v209, v4, v5, s44
  v_lshlrev_b32 v4, 4, v1
  s_lshl_b32 s44, s6, 13
  s_add_u32 s44, s44, 43008
  v_add_u32 v210, s44, v4
  s_lshl_b32 s44, s6, 10
  s_add_u32 s44, s44, 43008
  v_add_u32 v211, s44, v4
  s_lshl_b32 s44, s7, 13
  s_add_u32 s44, s44, 0
  v_lshl_add_u32 v213, v0, 4, s44
  s_mul_i32 s44, s3, 4608
  v_add_u32 v214, s44, v12
  s_lshr_b32 s44, s7, 3
  s_lshl_b32 s44, s44, 10
  s_bfe_u32 s45, s7, 0x10002
  s_lshl_b32 s45, s45, 9
  s_add_u32 s44, s44, s45
  s_and_b32 s45, s7, 3
  s_lshl_b32 s45, s45, 2
  s_add_u32 s44, s44, s45
  s_lshl_b32 s45, s6, 18
  s_add_u32 s44, s44, s45
  v_lshlrev_b32 v4, 16, v3
  v_lshl_add_u32 v4, v2, 4, v4
  v_add_u32 v212, s44, v4
  s_lshl_b32 s44, s7, 13
  s_lshl_b32 s45, s6, 10
  s_add_u32 s44, s44, s45
  s_add_u32 s44, s44, 17825792
  v_lshlrev_b32 v4, 8, v3
  v_lshl_add_u32 v4, v2, 4, v4
  v_add_u32 v215, s44, v4
  v_lshl_add_u32 v4, v3, 6, v2
  s_lshl_b32 s44, s6, 11
  s_add_u32 s44, s44, 17104896
  v_lshl_add_u32 v216, v4, 3, s44
  s_lshl_b32 s44, s5, 5
  v_add_u32 v217, s44, v1
  v_mul_u32_u24 v217, 1536, v217
  s_lshl_b32 s44, s4, 3
  s_add_u32 s44, s44, 17301504
  v_add_u32 v217, s44, v217
  v_lshrrev_b32 v4, 5, v1
  v_lshl_or_b32 v217, v4, 29, v217
  s_waitcnt lgkmcnt(0)
  s_lshr_b32 s44, s101, 16
  s_and_b32 s45, s101, 0xffff
  s_cmp_eq_u32 s61, 0
  s_cselect_b32 s44, s45, s44
  s_lshl_b32 s45, s44, 16
  v_lshlrev_b32 v4, 3, v3
  v_add_u32 v4, v4, v2
  v_sub_u32 v4, 15, v4
  v_and_b32 v5, 1, v4
  v_cmp_eq_u32 vcc, 1, v5
  v_mov_b32 v220, s44
  v_mov_b32 v221, s45
  v_cndmask_b32 v5, v220, v221, vcc
  v_ashrrev_i32 v4, 1, v4
  v_cmp_eq_u32 vcc, 0, v4
  s_nop 1
  v_cndmask_b32 v220, 0, v5, vcc
  v_cmp_eq_u32 vcc, 1, v4
  s_nop 1
  v_cndmask_b32 v221, 0, v5, vcc
  v_cmp_eq_u32 vcc, 2, v4
  s_nop 1
  v_cndmask_b32 v222, 0, v5, vcc
  v_cmp_eq_u32 vcc, 3, v4
  s_nop 1
  v_cndmask_b32 v223, 0, v5, vcc
  v_and_b32 v3, 127, v0
  v_mul_u32_u24 v4, 147, v3
  v_lshrrev_b32 v4, 10, v4
  v_mul_u32_u24 v5, 7, v4
  v_sub_u32 v5, v3, v5
  s_lshl_b32 s44, s4, 4
  v_add_u32 v4, s44, v4
  v_mul_u32_u24 v4, 3584, v4
  v_lshl_add_u32 v218, v5, 7, v4
  s_lshr_b32 s44, s5, 1
  s_mul_i32 s44, s44, 896
  v_add_u32 v218, s44, v218
  s_bitcmp1_b32 s6, 1
  s_cselect_b32 s40, s54, s52
  s_cselect_b32 s41, s55, s53
  s_mov_b32 s42, 1835008
  s_mov_b32 s43, 0x20000
  s_mul_i32 s44, s2, 7168
  v_lshl_add_u32 v219, v1, 7, s44
  s_mov_b32 s20, s56
  s_mov_b32 s21, s57
  s_mov_b32 s22, 1835008
  s_cmp_lg_u32 s6, 0
  s_cbranch_scc1 conv_kernel_s1w
  s_lshl_b32 s44, s5, 8
  s_add_u32 s44, s44, 17043456
  v_mov_b32 v4, s44
  s_mov_b32 s45, 200000
conv_kernel_s1_lp:
  buffer_load_dword v224, v4, s[28:31], 0 offen sc1
  s_waitcnt vmcnt(0)
  v_readfirstlane_b32 s44, v224
  s_nop 0
  s_cmp_ge_u32 s44, 32
  s_cbranch_scc1 conv_kernel_s1_ok
  s_sleep 1
  s_sub_u32 s45, s45, 1
  s_cmp_lg_u32 s45, 0
  s_cbranch_scc1 conv_kernel_s1_lp
conv_kernel_s1_ok:
conv_kernel_s1w:
  s_waitcnt lgkmcnt(0)
  s_barrier
  buffer_load_dwordx4 v[48:51], v213, s[28:31], 0 offen sc1
  s_cmp_ge_u32 s6, 4
  s_cbranch_scc1 conv_kernel_nohf
  ds_read_b64 v[112:113], v209 offset:0
  ds_read_b64 v[114:115], v209 offset:8
  ds_read_b64 v[116:117], v209 offset:512
  ds_read_b64 v[118:119], v209 offset:520
  ds_read_b64 v[120:121], v209 offset:1024
  ds_read_b64 v[122:123], v209 offset:1032
  ds_read_b64 v[124:125], v209 offset:1536
  ds_read_b64 v[126:127], v209 offset:1544
  ds_read_b64 v[128:129], v209 offset:2048
  ds_read_b64 v[130:131], v209 offset:2056
  ds_read_b64 v[132:133], v209 offset:2560
  ds_read_b64 v[134:135], v209 offset:2568
  ds_read_b64 v[136:137], v209 offset:3072
  ds_read_b64 v[138:139], v209 offset:3080
  ds_read_b64 v[140:141], v209 offset:3584
  ds_read_b64 v[142:143], v209 offset:3592
conv_kernel_nohf:
  s_waitcnt vmcnt(0)
  ds_write_b128 v214, v[48:51]
  s_waitcnt lgkmcnt(0)
  s_barrier
  s_cmp_ge_u32 s6, 4
  s_cbranch_scc1 conv_kernel_support
  ds_read_b128 v[48:51], v208 offset:3584
  ds_read_b128 v[52:55], v208 offset:3072
  ds_read_b128 v[56:59], v208 offset:2560
  ds_read_b128 v[60:63], v208 offset:2048
  ds_read_b128 v[64:67], v208 offset:1536
  ds_read_b128 v[68:71], v208 offset:1024
  ds_read_b128 v[72:75], v208 offset:512
  ds_read_b128 v[76:79], v208 offset:0
  buffer_load_dwordx4 v[176:179], v215, s[28:31], 0 offen sc1
  buffer_load_dwordx2 v[180:181], v216, s[28:31], 0 offen offset:0 sc1
  buffer_load_dwordx2 v[182:183], v216, s[28:31], 0 offen offset:128 sc1
  buffer_load_dwordx2 v[184:185], v216, s[28:31], 0 offen offset:256 sc1
  buffer_load_dwordx2 v[186:187], v216, s[28:31], 0 offen offset:384 sc1
  s_waitcnt lgkmcnt(0)
  s_cmp_lg_u32 s62, 0
  s_cbranch_scc1 conv_kernel_noD
  v_mfma_f32_16x16x32_bf16 v[16:19], v[48:51], v[220:223], 0
  v_mfma_f32_16x16x32_bf16 v[20:23], v[52:55], v[220:223], 0
  v_mfma_f32_16x16x32_bf16 v[24:27], v[56:59], v[220:223], 0
  v_mfma_f32_16x16x32_bf16 v[28:31], v[60:63], v[220:223], 0
  v_mfma_f32_16x16x32_bf16 v[32:35], v[64:67], v[220:223], 0
  v_mfma_f32_16x16x32_bf16 v[36:39], v[68:71], v[220:223], 0
  v_mfma_f32_16x16x32_bf16 v[40:43], v[72:75], v[220:223], 0
  v_mfma_f32_16x16x32_bf16 v[44:47], v[76:79], v[220:223], 0
  s_branch conv_kernel_Dok
conv_kernel_noD:
  v_mov_b32 v16, 0
  v_mov_b32 v17, 0
  v_mov_b32 v18, 0
  v_mov_b32 v19, 0
  v_mov_b32 v20, 0
  v_mov_b32 v21, 0
  v_mov_b32 v22, 0
  v_mov_b32 v23, 0
  v_mov_b32 v24, 0
  v_mov_b32 v25, 0
  v_mov_b32 v26, 0
  v_mov_b32 v27, 0
  v_mov_b32 v28, 0
  v_mov_b32 v29, 0
  v_mov_b32 v30, 0
  v_mov_b32 v31, 0
  v_mov_b32 v32, 0
  v_mov_b32 v33, 0
  v_mov_b32 v34, 0
  v_mov_b32 v35, 0
  v_mov_b32 v36, 0
  v_mov_b32 v37, 0
  v_mov_b32 v38, 0
  v_mov_b32 v39, 0
  v_mov_b32 v40, 0
  v_mov_b32 v41, 0
  v_mov_b32 v42, 0
  v_mov_b32 v43, 0
  v_mov_b32 v44, 0
  v_mov_b32 v45, 0
  v_mov_b32 v46, 0
  v_mov_b32 v47, 0
  s_nop 1
conv_kernel_Dok:
  v_mfma_f32_16x16x32_bf16 v[16:19], v[48:51], v[112:115], v[16:19]
  ds_read_b128 v[80:83], v208 offset:3648
  v_mfma_f32_16x16x32_bf16 v[20:23], v[52:55], v[112:115], v[20:23]
  ds_read_b128 v[84:87], v208 offset:3136
  v_mfma_f32_16x16x32_bf16 v[24:27], v[56:59], v[112:115], v[24:27]
  ds_read_b128 v[88:91], v208 offset:2624
  v_mfma_f32_16x16x32_bf16 v[28:31], v[60:63], v[112:115], v[28:31]
  ds_read_b128 v[92:95], v208 offset:2112
  v_mfma_f32_16x16x32_bf16 v[32:35], v[64:67], v[112:115], v[32:35]
  ds_read_b128 v[96:99], v208 offset:1600
  v_mfma_f32_16x16x32_bf16 v[36:39], v[68:71], v[112:115], v[36:39]
  ds_read_b128 v[100:103], v208 offset:1088
  v_mfma_f32_16x16x32_bf16 v[40:43], v[72:75], v[112:115], v[40:43]
  ds_read_b128 v[104:107], v208 offset:576
  v_mfma_f32_16x16x32_bf16 v[44:47], v[76:79], v[112:115], v[44:47]
  ds_read_b128 v[108:111], v208 offset:64
  v_mfma_f32_16x16x32_bf16 v[20:23], v[48:51], v[116:119], v[20:23]
  ds_read_b64 v[144:145], v209 offset:64
  v_mfma_f32_16x16x32_bf16 v[24:27], v[52:55], v[116:119], v[24:27]
  ds_read_b64 v[146:147], v209 offset:72
  v_mfma_f32_16x16x32_bf16 v[28:31], v[56:59], v[116:119], v[28:31]
  ds_read_b64 v[148:149], v209 offset:576
  v_mfma_f32_16x16x32_bf16 v[32:35], v[60:63], v[116:119], v[32:35]
  ds_read_b64 v[150:151], v209 offset:584
  v_mfma_f32_16x16x32_bf16 v[36:39], v[64:67], v[116:119], v[36:39]
  ds_read_b64 v[152:153], v209 offset:1088
  v_mfma_f32_16x16x32_bf16 v[40:43], v[68:71], v[116:119], v[40:43]
  ds_read_b64 v[154:155], v209 offset:1096
  v_mfma_f32_16x16x32_bf16 v[44:47], v[72:75], v[116:119], v[44:47]
  ds_read_b64 v[156:157], v209 offset:1600
  v_mfma_f32_16x16x32_bf16 v[24:27], v[48:51], v[120:123], v[24:27]
  ds_read_b64 v[158:159], v209 offset:1608
  v_mfma_f32_16x16x32_bf16 v[28:31], v[52:55], v[120:123], v[28:31]
  ds_read_b64 v[160:161], v209 offset:2112
  v_mfma_f32_16x16x32_bf16 v[32:35], v[56:59], v[120:123], v[32:35]
  ds_read_b64 v[162:163], v209 offset:2120
  v_mfma_f32_16x16x32_bf16 v[36:39], v[60:63], v[120:123], v[36:39]
  ds_read_b64 v[164:165], v209 offset:2624
  v_mfma_f32_16x16x32_bf16 v[40:43], v[64:67], v[120:123], v[40:43]
  ds_read_b64 v[166:167], v209 offset:2632
  v_mfma_f32_16x16x32_bf16 v[44:47], v[68:71], v[120:123], v[44:47]
  ds_read_b64 v[168:169], v209 offset:3136
  v_mfma_f32_16x16x32_bf16 v[28:31], v[48:51], v[124:127], v[28:31]
  ds_read_b64 v[170:171], v209 offset:3144
  v_mfma_f32_16x16x32_bf16 v[32:35], v[52:55], v[124:127], v[32:35]
  ds_read_b64 v[172:173], v209 offset:3648
  v_mfma_f32_16x16x32_bf16 v[36:39], v[56:59], v[124:127], v[36:39]
  ds_read_b64 v[174:175], v209 offset:3656
  v_mfma_f32_16x16x32_bf16 v[40:43], v[60:63], v[124:127], v[40:43]
  v_mfma_f32_16x16x32_bf16 v[44:47], v[64:67], v[124:127], v[44:47]
  v_mfma_f32_16x16x32_bf16 v[32:35], v[48:51], v[128:131], v[32:35]
  v_mfma_f32_16x16x32_bf16 v[36:39], v[52:55], v[128:131], v[36:39]
  v_mfma_f32_16x16x32_bf16 v[40:43], v[56:59], v[128:131], v[40:43]
  v_mfma_f32_16x16x32_bf16 v[44:47], v[60:63], v[128:131], v[44:47]
  v_mfma_f32_16x16x32_bf16 v[36:39], v[48:51], v[132:135], v[36:39]
  v_mfma_f32_16x16x32_bf16 v[40:43], v[52:55], v[132:135], v[40:43]
  v_mfma_f32_16x16x32_bf16 v[44:47], v[56:59], v[132:135], v[44:47]
  v_mfma_f32_16x16x32_bf16 v[40:43], v[48:51], v[136:139], v[40:43]
  v_mfma_f32_16x16x32_bf16 v[44:47], v[52:55], v[136:139], v[44:47]
  v_mfma_f32_16x16x32_bf16 v[44:47], v[48:51], v[140:143], v[44:47]
  s_waitcnt lgkmcnt(0)
  v_mfma_f32_16x16x32_bf16 v[16:19], v[80:83], v[144:147], v[16:19]
  ds_read_b128 v[48:51], v208 offset:3712
  v_mfma_f32_16x16x32_bf16 v[20:23], v[84:87], v[144:147], v[20:23]
  ds_read_b128 v[52:55], v208 offset:3200
  v_mfma_f32_16x16x32_bf16 v[24:27], v[88:91], v[144:147], v[24:27]
  ds_read_b128 v[56:59], v208 offset:2688
  v_mfma_f32_16x16x32_bf16 v[28:31], v[92:95], v[144:147], v[28:31]
  ds_read_b128 v[60:63], v208 offset:2176
  v_mfma_f32_16x16x32_bf16 v[32:35], v[96:99], v[144:147], v[32:35]
  ds_read_b128 v[64:67], v208 offset:1664
  v_mfma_f32_16x16x32_bf16 v[36:39], v[100:103], v[144:147], v[36:39]
  ds_read_b128 v[68:71], v208 offset:1152
  v_mfma_f32_16x16x32_bf16 v[40:43], v[104:107], v[144:147], v[40:43]
  ds_read_b128 v[72:75], v208 offset:640
  v_mfma_f32_16x16x32_bf16 v[44:47], v[108:111], v[144:147], v[44:47]
  ds_read_b128 v[76:79], v208 offset:128
  v_mfma_f32_16x16x32_bf16 v[20:23], v[80:83], v[148:151], v[20:23]
  ds_read_b64 v[112:113], v209 offset:128
  v_mfma_f32_16x16x32_bf16 v[24:27], v[84:87], v[148:151], v[24:27]
  ds_read_b64 v[114:115], v209 offset:136
  v_mfma_f32_16x16x32_bf16 v[28:31], v[88:91], v[148:151], v[28:31]
  ds_read_b64 v[116:117], v209 offset:640
  v_mfma_f32_16x16x32_bf16 v[32:35], v[92:95], v[148:151], v[32:35]
  ds_read_b64 v[118:119], v209 offset:648
  v_mfma_f32_16x16x32_bf16 v[36:39], v[96:99], v[148:151], v[36:39]
  ds_read_b64 v[120:121], v209 offset:1152
  v_mfma_f32_16x16x32_bf16 v[40:43], v[100:103], v[148:151], v[40:43]
  ds_read_b64 v[122:123], v209 offset:1160
  v_mfma_f32_16x16x32_bf16 v[44:47], v[104:107], v[148:151], v[44:47]
  ds_read_b64 v[124:125], v209 offset:1664
  v_mfma_f32_16x16x32_bf16 v[24:27], v[80:83], v[152:155], v[24:27]
  ds_read_b64 v[126:127], v209 offset:1672
  v_mfma_f32_16x16x32_bf16 v[28:31], v[84:87], v[152:155], v[28:31]
  ds_read_b64 v[128:129], v209 offset:2176
  v_mfma_f32_16x16x32_bf16 v[32:35], v[88:91], v[152:155], v[32:35]
  ds_read_b64 v[130:131], v209 offset:2184
  v_mfma_f32_16x16x32_bf16 v[36:39], v[92:95], v[152:155], v[36:39]
  ds_read_b64 v[132:133], v209 offset:2688
  v_mfma_f32_16x16x32_bf16 v[40:43], v[96:99], v[152:155], v[40:43]
  ds_read_b64 v[134:135], v209 offset:2696
  v_mfma_f32_16x16x32_bf16 v[44:47], v[100:103], v[152:155], v[44:47]
  ds_read_b64 v[136:137], v209 offset:3200
  v_mfma_f32_16x16x32_bf16 v[28:31], v[80:83], v[156:159], v[28:31]
  ds_read_b64 v[138:139], v209 offset:3208
  v_mfma_f32_16x16x32_bf16 v[32:35], v[84:87], v[156:159], v[32:35]
  ds_read_b64 v[140:141], v209 offset:3712
  v_mfma_f32_16x16x32_bf16 v[36:39], v[88:91], v[156:159], v[36:39]
  ds_read_b64 v[142:143], v209 offset:3720
  v_mfma_f32_16x16x32_bf16 v[40:43], v[92:95], v[156:159], v[40:43]
  v_mfma_f32_16x16x32_bf16 v[44:47], v[96:99], v[156:159], v[44:47]
  v_mfma_f32_16x16x32_bf16 v[32:35], v[80:83], v[160:163], v[32:35]
  v_mfma_f32_16x16x32_bf16 v[36:39], v[84:87], v[160:163], v[36:39]
  v_mfma_f32_16x16x32_bf16 v[40:43], v[88:91], v[160:163], v[40:43]
  v_mfma_f32_16x16x32_bf16 v[44:47], v[92:95], v[160:163], v[44:47]
  v_mfma_f32_16x16x32_bf16 v[36:39], v[80:83], v[164:167], v[36:39]
  v_mfma_f32_16x16x32_bf16 v[40:43], v[84:87], v[164:167], v[40:43]
  v_mfma_f32_16x16x32_bf16 v[44:47], v[88:91], v[164:167], v[44:47]
  v_mfma_f32_16x16x32_bf16 v[40:43], v[80:83], v[168:171], v[40:43]
  v_mfma_f32_16x16x32_bf16 v[44:47], v[84:87], v[168:171], v[44:47]
  v_mfma_f32_16x16x32_bf16 v[44:47], v[80:83], v[172:175], v[44:47]
  s_waitcnt lgkmcnt(0)
  v_mfma_f32_16x16x32_bf16 v[16:19], v[48:51], v[112:115], v[16:19]
  ds_read_b128 v[80:83], v208 offset:3776
  v_mfma_f32_16x16x32_bf16 v[20:23], v[52:55], v[112:115], v[20:23]
  ds_read_b128 v[84:87], v208 offset:3264
  v_mfma_f32_16x16x32_bf16 v[24:27], v[56:59], v[112:115], v[24:27]
  ds_read_b128 v[88:91], v208 offset:2752
  v_mfma_f32_16x16x32_bf16 v[28:31], v[60:63], v[112:115], v[28:31]
  ds_read_b128 v[92:95], v208 offset:2240
  v_mfma_f32_16x16x32_bf16 v[32:35], v[64:67], v[112:115], v[32:35]
  ds_read_b128 v[96:99], v208 offset:1728
  v_mfma_f32_16x16x32_bf16 v[36:39], v[68:71], v[112:115], v[36:39]
  ds_read_b128 v[100:103], v208 offset:1216
  v_mfma_f32_16x16x32_bf16 v[40:43], v[72:75], v[112:115], v[40:43]
  ds_read_b128 v[104:107], v208 offset:704
  v_mfma_f32_16x16x32_bf16 v[44:47], v[76:79], v[112:115], v[44:47]
  ds_read_b128 v[108:111], v208 offset:192
  v_mfma_f32_16x16x32_bf16 v[20:23], v[48:51], v[116:119], v[20:23]
  ds_read_b64 v[144:145], v209 offset:192
  v_mfma_f32_16x16x32_bf16 v[24:27], v[52:55], v[116:119], v[24:27]
  ds_read_b64 v[146:147], v209 offset:200
  v_mfma_f32_16x16x32_bf16 v[28:31], v[56:59], v[116:119], v[28:31]
  ds_read_b64 v[148:149], v209 offset:704
  v_mfma_f32_16x16x32_bf16 v[32:35], v[60:63], v[116:119], v[32:35]
  ds_read_b64 v[150:151], v209 offset:712
  v_mfma_f32_16x16x32_bf16 v[36:39], v[64:67], v[116:119], v[36:39]
  ds_read_b64 v[152:153], v209 offset:1216
  v_mfma_f32_16x16x32_bf16 v[40:43], v[68:71], v[116:119], v[40:43]
  ds_read_b64 v[154:155], v209 offset:1224
  v_mfma_f32_16x16x32_bf16 v[44:47], v[72:75], v[116:119], v[44:47]
  ds_read_b64 v[156:157], v209 offset:1728
  v_mfma_f32_16x16x32_bf16 v[24:27], v[48:51], v[120:123], v[24:27]
  ds_read_b64 v[158:159], v209 offset:1736
  v_mfma_f32_16x16x32_bf16 v[28:31], v[52:55], v[120:123], v[28:31]
  ds_read_b64 v[160:161], v209 offset:2240
  v_mfma_f32_16x16x32_bf16 v[32:35], v[56:59], v[120:123], v[32:35]
  ds_read_b64 v[162:163], v209 offset:2248
  v_mfma_f32_16x16x32_bf16 v[36:39], v[60:63], v[120:123], v[36:39]
  ds_read_b64 v[164:165], v209 offset:2752
  v_mfma_f32_16x16x32_bf16 v[40:43], v[64:67], v[120:123], v[40:43]
  ds_read_b64 v[166:167], v209 offset:2760
  v_mfma_f32_16x16x32_bf16 v[44:47], v[68:71], v[120:123], v[44:47]
  ds_read_b64 v[168:169], v209 offset:3264
  v_mfma_f32_16x16x32_bf16 v[28:31], v[48:51], v[124:127], v[28:31]
  ds_read_b64 v[170:171], v209 offset:3272
  v_mfma_f32_16x16x32_bf16 v[32:35], v[52:55], v[124:127], v[32:35]
  ds_read_b64 v[172:173], v209 offset:3776
  v_mfma_f32_16x16x32_bf16 v[36:39], v[56:59], v[124:127], v[36:39]
  ds_read_b64 v[174:175], v209 offset:3784
  v_mfma_f32_16x16x32_bf16 v[40:43], v[60:63], v[124:127], v[40:43]
  v_mfma_f32_16x16x32_bf16 v[44:47], v[64:67], v[124:127], v[44:47]
  v_mfma_f32_16x16x32_bf16 v[32:35], v[48:51], v[128:131], v[32:35]
  v_mfma_f32_16x16x32_bf16 v[36:39], v[52:55], v[128:131], v[36:39]
  v_mfma_f32_16x16x32_bf16 v[40:43], v[56:59], v[128:131], v[40:43]
  v_mfma_f32_16x16x32_bf16 v[44:47], v[60:63], v[128:131], v[44:47]
  v_mfma_f32_16x16x32_bf16 v[36:39], v[48:51], v[132:135], v[36:39]
  v_mfma_f32_16x16x32_bf16 v[40:43], v[52:55], v[132:135], v[40:43]
  v_mfma_f32_16x16x32_bf16 v[44:47], v[56:59], v[132:135], v[44:47]
  v_mfma_f32_16x16x32_bf16 v[40:43], v[48:51], v[136:139], v[40:43]
  v_mfma_f32_16x16x32_bf16 v[44:47], v[52:55], v[136:139], v[44:47]
  v_mfma_f32_16x16x32_bf16 v[44:47], v[48:51], v[140:143], v[44:47]
  s_waitcnt lgkmcnt(0)
  v_mfma_f32_16x16x32_bf16 v[16:19], v[80:83], v[144:147], v[16:19]
  v_mfma_f32_16x16x32_bf16 v[20:23], v[84:87], v[144:147], v[20:23]
  v_mfma_f32_16x16x32_bf16 v[24:27], v[88:91], v[144:147], v[24:27]
  v_mfma_f32_16x16x32_bf16 v[28:31], v[92:95], v[144:147], v[28:31]
  v_mfma_f32_16x16x32_bf16 v[32:35], v[96:99], v[144:147], v[32:35]
  v_mfma_f32_16x16x32_bf16 v[36:39], v[100:103], v[144:147], v[36:39]
  v_mfma_f32_16x16x32_bf16 v[40:43], v[104:107], v[144:147], v[40:43]
  v_mfma_f32_16x16x32_bf16 v[44:47], v[108:111], v[144:147], v[44:47]
  v_mfma_f32_16x16x32_bf16 v[20:23], v[80:83], v[148:151], v[20:23]
  v_mfma_f32_16x16x32_bf16 v[24:27], v[84:87], v[148:151], v[24:27]
  v_mfma_f32_16x16x32_bf16 v[28:31], v[88:91], v[148:151], v[28:31]
  v_mfma_f32_16x16x32_bf16 v[32:35], v[92:95], v[148:151], v[32:35]
  v_mfma_f32_16x16x32_bf16 v[36:39], v[96:99], v[148:151], v[36:39]
  v_mfma_f32_16x16x32_bf16 v[40:43], v[100:103], v[148:151], v[40:43]
  v_mfma_f32_16x16x32_bf16 v[44:47], v[104:107], v[148:151], v[44:47]
  v_mfma_f32_16x16x32_bf16 v[24:27], v[80:83], v[152:155], v[24:27]
  v_mfma_f32_16x16x32_bf16 v[28:31], v[84:87], v[152:155], v[28:31]
  v_mfma_f32_16x16x32_bf16 v[32:35], v[88:91], v[152:155], v[32:35]
  v_mfma_f32_16x16x32_bf16 v[36:39], v[92:95], v[152:155], v[36:39]
  v_mfma_f32_16x16x32_bf16 v[40:43], v[96:99], v[152:155], v[40:43]
  v_mfma_f32_16x16x32_bf16 v[44:47], v[100:103], v[152:155], v[44:47]
  v_mfma_f32_16x16x32_bf16 v[28:31], v[80:83], v[156:159], v[28:31]
  v_mfma_f32_16x16x32_bf16 v[32:35], v[84:87], v[156:159], v[32:35]
  v_mfma_f32_16x16x32_bf16 v[36:39], v[88:91], v[156:159], v[36:39]
  v_mfma_f32_16x16x32_bf16 v[40:43], v[92:95], v[156:159], v[40:43]
  v_mfma_f32_16x16x32_bf16 v[44:47], v[96:99], v[156:159], v[44:47]
  v_mfma_f32_16x16x32_bf16 v[32:35], v[80:83], v[160:163], v[32:35]
  v_mfma_f32_16x16x32_bf16 v[36:39], v[84:87], v[160:163], v[36:39]
  v_mfma_f32_16x16x32_bf16 v[40:43], v[88:91], v[160:163], v[40:43]
  v_mfma_f32_16x16x32_bf16 v[44:47], v[92:95], v[160:163], v[44:47]
  v_mfma_f32_16x16x32_bf16 v[36:39], v[80:83], v[164:167], v[36:39]
  v_mfma_f32_16x16x32_bf16 v[40:43], v[84:87], v[164:167], v[40:43]
  v_mfma_f32_16x16x32_bf16 v[44:47], v[88:91], v[164:167], v[44:47]
  v_mfma_f32_16x16x32_bf16 v[40:43], v[80:83], v[168:171], v[40:43]
  v_mfma_f32_16x16x32_bf16 v[44:47], v[84:87], v[168:171], v[44:47]
  v_mfma_f32_16x16x32_bf16 v[44:47], v[80:83], v[172:175], v[44:47]
  s_nop 7
  ds_write_b128 v210, v[16:19] offset:0
  ds_write_b128 v210, v[20:23] offset:1024
  ds_write_b128 v210, v[24:27] offset:2048
  ds_write_b128 v210, v[28:31] offset:3072
  ds_write_b128 v210, v[32:35] offset:4096
  ds_write_b128 v210, v[36:39] offset:5120
  ds_write_b128 v210, v[40:43] offset:6144
  ds_write_b128 v210, v[44:47] offset:7168
  s_waitcnt vmcnt(0)
  s_branch conv_kernel_join
conv_kernel_support:
  s_cmp_lg_u32 s6, 4
  s_cbranch_scc1 conv_kernel_nopt
  buffer_load_dwordx2 v[196:197], v217, s[28:31], 0 offen offset:0 sc1
  buffer_load_dwordx2 v[198:199], v217, s[28:31], 0 offen offset:256 sc1
  buffer_load_dwordx2 v[200:201], v217, s[28:31], 0 offen offset:512 sc1
  buffer_load_dwordx2 v[202:203], v217, s[28:31], 0 offen offset:768 sc1
  buffer_load_dwordx2 v[204:205], v217, s[28:31], 0 offen offset:1024 sc1
  buffer_load_dwordx2 v[206:207], v217, s[28:31], 0 offen offset:1280 sc1
conv_kernel_nopt:
  buffer_load_dwordx4 v[176:179], v215, s[28:31], 0 offen sc1
  buffer_load_dwordx2 v[180:181], v216, s[28:31], 0 offen offset:0 sc1
  buffer_load_dwordx2 v[182:183], v216, s[28:31], 0 offen offset:128 sc1
  buffer_load_dwordx2 v[184:185], v216, s[28:31], 0 offen offset:256 sc1
  buffer_load_dwordx2 v[186:187], v216, s[28:31], 0 offen offset:384 sc1
  s_waitcnt vmcnt(0)
  buffer_load_dword v228, v218, s[40:43], 0 offen
  s_cmp_lg_u32 s6, 5
  s_cbranch_scc1 conv_kernel_nopd
  buffer_load_dword v229, v219, s[20:23], 0 offen
conv_kernel_nopd:
  s_cmp_lg_u32 s6, 4
  s_cbranch_scc1 conv_kernel_join
  v_permlane16_swap_b32 v196, v197
  v_permlane16_swap_b32 v198, v199
  v_permlane16_swap_b32 v200, v201
  v_permlane16_swap_b32 v202, v203
  v_permlane16_swap_b32 v204, v205
  v_permlane16_swap_b32 v206, v207
  v_add_f32 v196, v196, v197
  v_add_f32 v198, v198, v199
  v_add_f32 v200, v200, v201
  v_add_f32 v202, v202, v203
  v_add_f32 v204, v204, v205
  v_add_f32 v206, v206, v207
  v_add_f32_dpp v196, v196, v196 row_ror:8 row_mask:0xf bank_mask:0xf
  v_add_f32_dpp v198, v198, v198 row_ror:8 row_mask:0xf bank_mask:0xf
  v_add_f32_dpp v200, v200, v200 row_ror:8 row_mask:0xf bank_mask:0xf
  v_add_f32_dpp v202, v202, v202 row_ror:8 row_mask:0xf bank_mask:0xf
  v_add_f32_dpp v204, v204, v204 row_ror:8 row_mask:0xf bank_mask:0xf
  v_add_f32_dpp v206, v206, v206 row_ror:8 row_mask:0xf bank_mask:0xf
  v_add_f32_dpp v196, v196, v196 row_ror:4 row_mask:0xf bank_mask:0xf
  v_add_f32_dpp v198, v198, v198 row_ror:4 row_mask:0xf bank_mask:0xf
  v_add_f32_dpp v200, v200, v200 row_ror:4 row_mask:0xf bank_mask:0xf
  v_add_f32_dpp v202, v202, v202 row_ror:4 row_mask:0xf bank_mask:0xf
  v_add_f32_dpp v204, v204, v204 row_ror:4 row_mask:0xf bank_mask:0xf
  v_add_f32_dpp v206, v206, v206 row_ror:4 row_mask:0xf bank_mask:0xf
  v_add_f32_dpp v196, v196, v196 row_ror:2 row_mask:0xf bank_mask:0xf
  v_add_f32_dpp v198, v198, v198 row_ror:2 row_mask:0xf bank_mask:0xf
  v_add_f32_dpp v200, v200, v200 row_ror:2 row_mask:0xf bank_mask:0xf
  v_add_f32_dpp v202, v202, v202 row_ror:2 row_mask:0xf bank_mask:0xf
  v_add_f32_dpp v204, v204, v204 row_ror:2 row_mask:0xf bank_mask:0xf
  v_add_f32_dpp v206, v206, v206 row_ror:2 row_mask:0xf bank_mask:0xf
  v_add_f32_dpp v196, v196, v196 row_ror:1 row_mask:0xf bank_mask:0xf
  v_add_f32_dpp v198, v198, v198 row_ror:1 row_mask:0xf bank_mask:0xf
  v_add_f32_dpp v200, v200, v200 row_ror:1 row_mask:0xf bank_mask:0xf
  v_add_f32_dpp v202, v202, v202 row_ror:1 row_mask:0xf bank_mask:0xf
  v_add_f32_dpp v204, v204, v204 row_ror:1 row_mask:0xf bank_mask:0xf
  v_add_f32_dpp v206, v206, v206 row_ror:1 row_mask:0xf bank_mask:0xf
  v_cvt_pk_bf16_f32 v196, v196, v196
  v_cvt_pk_bf16_f32 v198, v198, v198
  v_cvt_pk_bf16_f32 v200, v200, v200
  v_cvt_pk_bf16_f32 v202, v202, v202
  v_cvt_pk_bf16_f32 v204, v204, v204
  v_cvt_pk_bf16_f32 v206, v206, v206
  v_lshlrev_b32 v196, 16, v196
  v_lshlrev_b32 v198, 16, v198
  v_lshlrev_b32 v200, 16, v200
  v_lshlrev_b32 v202, 16, v202
  v_lshlrev_b32 v204, 16, v204
  v_lshlrev_b32 v206, 16, v206
  v_add_f32 v198, 1.0, v198
  v_add_f32 v204, 1.0, v204
  v_cvt_pk_bf16_f32 v198, v198, v198
  v_cvt_pk_bf16_f32 v204, v204, v204
  v_lshlrev_b32 v198, 16, v198
  v_lshlrev_b32 v204, 16, v204
  v_lshrrev_b32 v197, 4, v1
  v_lshlrev_b32 v197, 2, v197
  v_add_u32 v197, 42496, v197
  s_mov_b64 exec, 0x10001
  ds_write_b32 v197, v196 offset:0
  ds_write_b32 v197, v198 offset:8
  ds_write_b32 v197, v200 offset:16
  ds_write_b32 v197, v204 offset:24
  s_mov_b64 exec, -1
  v_lshrrev_b32 v197, 4, v1
  s_lshl_b32 s44, s7, 1
  v_add_u32 v197, s44, v197
  v_lshlrev_b32 v199, 2, v197
  v_lshlrev_b32 v201, 1, v197
  s_mov_b64 exec, 0x10001
  s_mov_b32 s44, 16777216
  buffer_store_dword v196, v199, s[28:31], s44 offen
  s_mov_b32 s44, 16779264
  buffer_store_dword v198, v199, s[28:31], s44 offen
  s_mov_b32 s44, 16781312
  buffer_store_dword v200, v199, s[28:31], s44 offen
  s_mov_b32 s44, 16783360
  buffer_store_dword v202, v199, s[28:31], s44 offen
  s_mov_b32 s44, 16785408
  buffer_store_dword v204, v199, s[28:31], s44 offen
  s_mov_b32 s44, 16787456
  buffer_store_dword v206, v199, s[28:31], s44 offen
  v_lshrrev_b32 v203, 16, v202
  s_mov_b32 s44, 16813056
  buffer_store_short v203, v201, s[28:31], s44 offen
  s_nop 0
  v_lshrrev_b32 v203, 16, v204
  s_mov_b32 s44, 16814080
  buffer_store_short v203, v201, s[28:31], s44 offen
  s_nop 0
  s_mov_b64 exec, -1
conv_kernel_join:
  s_mov_b32 s46, 200000
conv_kernel_val:
  v_min_u32 v112, v180, v182
  v_min3_u32 v112, v112, v184, v186
  v_cmp_eq_u32 vcc, 0, v112
  s_nop 1
  s_cmp_eq_u64 vcc, 0
  s_cbranch_scc1 conv_kernel_valok
  s_sleep 1
  buffer_load_dwordx2 v[180:181], v216, s[28:31], 0 offen offset:0 sc1
  buffer_load_dwordx2 v[182:183], v216, s[28:31], 0 offen offset:128 sc1
  buffer_load_dwordx2 v[184:185], v216, s[28:31], 0 offen offset:256 sc1
  buffer_load_dwordx2 v[186:187], v216, s[28:31], 0 offen offset:384 sc1
  s_waitcnt vmcnt(0)
  s_sub_u32 s46, s46, 1
  s_cmp_lg_u32 s46, 0
  s_cbranch_scc1 conv_kernel_val
conv_kernel_valok:
  v_lshlrev_b32 v120, 16, v176
  v_and_b32 v121, 0xffff0000, v176
  v_lshlrev_b32 v122, 16, v177
  v_and_b32 v123, 0xffff0000, v177
  v_lshlrev_b32 v124, 16, v178
  v_and_b32 v125, 0xffff0000, v178
  v_lshlrev_b32 v126, 16, v179
  v_and_b32 v127, 0xffff0000, v179
  v_pk_add_f32 v[128:129], v[120:121], v[180:181] op_sel:[0,1] op_sel_hi:[1,1] neg_lo:[0,1] neg_hi:[0,1]
  v_pk_add_f32 v[130:131], v[122:123], v[182:183] op_sel:[0,1] op_sel_hi:[1,1] neg_lo:[0,1] neg_hi:[0,1]
  v_pk_add_f32 v[132:133], v[124:125], v[184:185] op_sel:[0,1] op_sel_hi:[1,1] neg_lo:[0,1] neg_hi:[0,1]
  v_pk_add_f32 v[134:135], v[126:127], v[186:187] op_sel:[0,1] op_sel_hi:[1,1] neg_lo:[0,1] neg_hi:[0,1]
  v_pk_mul_f32 v[128:129], v[128:129], v[180:181] op_sel_hi:[1,0]
  v_pk_mul_f32 v[130:131], v[130:131], v[182:183] op_sel_hi:[1,0]
  v_pk_mul_f32 v[132:133], v[132:133], v[184:185] op_sel_hi:[1,0]
  v_pk_mul_f32 v[134:135], v[134:135], v[186:187] op_sel_hi:[1,0]
  s_waitcnt lgkmcnt(0)
  s_barrier
  v_mov_b32 v4, 42496
  ds_read_b128 v[188:191], v4
  ds_read_b128 v[192:195], v4 offset:16
  ds_read_b128 v[48:51], v211 offset:0
  ds_read_b128 v[52:55], v211 offset:8192
  ds_read_b128 v[64:67], v211 offset:16384
  ds_read_b128 v[68:71], v211 offset:24576
  s_waitcnt lgkmcnt(4)
  v_pk_fma_f32 v[128:129], v[128:129], v[190:191], v[188:189]
  v_pk_fma_f32 v[130:131], v[130:131], v[190:191], v[188:189]
  v_pk_fma_f32 v[132:133], v[132:133], v[190:191], v[188:189]
  v_pk_fma_f32 v[134:135], v[134:135], v[190:191], v[188:189]
  v_pk_mul_f32 v[128:129], v[128:129], v[192:193]
  v_pk_mul_f32 v[130:131], v[130:131], v[192:193]
  v_pk_mul_f32 v[132:133], v[132:133], v[192:193]
  v_pk_mul_f32 v[134:135], v[134:135], v[192:193]
  s_waitcnt lgkmcnt(0)
  v_pk_add_f32 v[48:49], v[48:49], v[52:53]
  v_pk_add_f32 v[64:65], v[64:65], v[68:69]
  v_pk_add_f32 v[50:51], v[50:51], v[54:55]
  v_pk_add_f32 v[66:67], v[66:67], v[70:71]
  v_fma_f32 v120, v128, v48, v120
  v_fma_f32 v121, v129, v64, v121
  v_fma_f32 v122, v130, v49, v122
  v_fma_f32 v123, v131, v65, v123
  v_fma_f32 v124, v132, v50, v124
  v_fma_f32 v125, v133, v66, v125
  v_fma_f32 v126, v134, v51, v126
  v_fma_f32 v127, v135, v67, v127
  v_cvt_pk_bf16_f32 v52, v120, v121
  v_cvt_pk_bf16_f32 v53, v122, v123
  v_cvt_pk_bf16_f32 v54, v124, v125
  v_cvt_pk_bf16_f32 v55, v126, v127
  s_mov_b32 s44, 4194304
  s_mov_b32 s45, 4227072
  s_mov_b32 s46, 6291456
  s_mov_b32 s47, 6324224
  buffer_store_dword v52, v212, s[28:31], s44 offen offset:0
  buffer_store_dword v53, v212, s[28:31], s44 offen offset:256
  buffer_store_dword v54, v212, s[28:31], s45 offen offset:0
  buffer_store_dword v55, v212, s[28:31], s45 offen offset:256
  v_lshlrev_b32 v120, 16, v52
  v_and_b32 v121, 0xffff0000, v52
  v_lshlrev_b32 v122, 16, v53
  v_and_b32 v123, 0xffff0000, v53
  v_lshlrev_b32 v124, 16, v54
  v_and_b32 v125, 0xffff0000, v54
  v_lshlrev_b32 v126, 16, v55
  v_and_b32 v127, 0xffff0000, v55
  v_pk_add_f32 v[120:121], v[120:121], v[180:181] op_sel:[0,1] op_sel_hi:[1,1] neg_lo:[0,1] neg_hi:[0,1]
  v_pk_add_f32 v[122:123], v[122:123], v[182:183] op_sel:[0,1] op_sel_hi:[1,1] neg_lo:[0,1] neg_hi:[0,1]
  v_pk_add_f32 v[124:125], v[124:125], v[184:185] op_sel:[0,1] op_sel_hi:[1,1] neg_lo:[0,1] neg_hi:[0,1]
  v_pk_add_f32 v[126:127], v[126:127], v[186:187] op_sel:[0,1] op_sel_hi:[1,1] neg_lo:[0,1] neg_hi:[0,1]
  v_pk_mul_f32 v[120:121], v[120:121], v[194:195]
  v_pk_mul_f32 v[122:123], v[122:123], v[194:195]
  v_pk_mul_f32 v[124:125], v[124:125], v[194:195]
  v_pk_mul_f32 v[126:127], v[126:127], v[194:195]
  v_cvt_pk_bf16_f32 v56, v120, v121
  v_cvt_pk_bf16_f32 v57, v122, v123
  v_cvt_pk_bf16_f32 v58, v124, v125
  v_cvt_pk_bf16_f32 v59, v126, v127
  buffer_store_dword v56, v212, s[28:31], s46 offen offset:0
  buffer_store_dword v57, v212, s[28:31], s46 offen offset:256
  buffer_store_dword v58, v212, s[28:31], s47 offen offset:0
  buffer_store_dword v59, v212, s[28:31], s47 offen offset:256
conv_kernel_end:
  s_endpgm
.text
.globl ffn_kernel
.p2align 8
.type ffn_kernel,@function
ffn_kernel:
  s_cmp_ge_u32 s2, 256
  s_cbranch_scc1 ffn_kernel_end
  s_load_dwordx4 s[4:7], s[0:1], 56
  s_load_dwordx2 s[32:33], s[0:1], 72
  s_load_dwordx2 s[34:35], s[0:1], 112
  s_load_dwordx2 s[36:37], s[0:1], 96
  v_lshrrev_b32 v5, 6, v0
  v_and_b32 v1, 63, v0
  v_readfirstlane_b32 s40, v5
  s_and_b32 s3, s2, 7
  s_lshr_b32 s47, s2, 3
  s_and_b32 s51, s47, 7
  s_lshr_b32 s48, s47, 3
  s_lshl_b32 s52, s3, 2
  s_add_u32 s52, s52, s48
  s_lshr_b32 s53, s40, 1
  s_and_b32 s54, s40, 1
  s_mov_b32 s41, s54
  s_cmp_ge_u32 s2, 224
  s_cbranch_scc1 ffn_kernel_helper
  s_mul_i32 s48, s47, 37
  s_lshr_b32 s48, s48, 8
  s_mul_i32 s49, s48, 7
  s_sub_u32 s49, s47, s49
  s_and_b32 s50, s3, 1
  s_lshl_b32 s50, s50, 2
  s_add_u32 s45, s50, s48
  s_lshr_b32 s50, s3, 1
  s_mul_i32 s50, s50, 7
  s_add_u32 s50, s50, s49
  s_lshl_b32 s44, s50, 6
  v_lshrrev_b32 v5, 3, v1
  v_bfe_u32 v6, v1, 4, 1
  s_lshl_b32 s47, s41, 1
  v_bfe_u32 v7, v1, 1, 2
  v_or_b32 v6, s47, v6
  v_xor_b32 v6, v6, v7
  v_and_b32 v7, 1, v1
  v_lshlrev_b32 v6, 5, v6
  v_lshl_add_u32 v6, v7, 4, v6
  s_movk_i32 s47, 3584
  v_mad_u32_u24 v2, v5, s47, v6
  s_lshl_b32 s57, s45, 3
  s_add_u32 s57, s57, s40
  s_lshl_b32 s48, s57, 15
  v_lshlrev_b32 v5, 4, v1
  v_add_u32 v3, s48, v5
  s_mul_i32 s42, s53, 57344
  s_lshl_b32 s48, s44, 1
  s_add_u32 s42, s42, s48
  s_lshl_b32 s43, s53, 11
  s_lshl_b32 s48, s41, 16
  s_add_u32 s43, s43, s48
  s_mov_b32 s46, 0
  s_waitcnt lgkmcnt(0)
  s_cmp_eq_u32 s41, 0
  s_cselect_b32 s8, s4, s6
  s_cselect_b32 s9, s5, s7
  s_mov_b32 s10, 1835008
  s_mov_b32 s11, 0x20000
  s_add_u32 s12, s34, 0x600000
  s_addc_u32 s13, s35, 0
  s_mov_b32 s14, 0x200000
  s_mov_b32 s15, 0x20000
  s_add_u32 m0, s43, 0
  s_nop 0
  buffer_load_dwordx4 v2, s[8:11], s42 offen lds
  s_add_u32 m0, s43, 1024
  s_add_u32 s42, s42, 28672
  buffer_load_dwordx4 v2, s[8:11], s42 offen lds
  buffer_load_dwordx4 a[0:3], v3, s[12:15], s46 offen offset:0
  buffer_load_dwordx4 a[4:7], v3, s[12:15], s46 offen offset:1024
  buffer_load_dwordx4 a[8:11], v3, s[12:15], s46 offen offset:2048
  buffer_load_dwordx4 a[12:15], v3, s[12:15], s46 offen offset:3072
  s_add_u32 s46, s46, 4096
  s_add_u32 s16, s34, 0x800000
  s_addc_u32 s17, s35, 0
  s_mov_b32 s18, 0x700000
  s_mov_b32 s19, 0x20000
  s_mov_b32 s20, s32
  s_mov_b32 s21, s33
  s_mov_b32 s22, 0x1c0000
  s_mov_b32 s23, 0x20000
  s_add_u32 s24, s34, 0x1040000
  s_addc_u32 s25, s35, 0
  s_mov_b32 s26, 0x1000
  s_mov_b32 s27, 0x20000
  v_bfe_u32 v6, v1, 2, 2
  v_lshrrev_b32 v7, 5, v1
  v_lshl_add_u32 v7, v7, 3, v6
  v_bfe_u32 v8, v1, 4, 1
  v_lshlrev_b32 v7, 7, v7
  v_lshl_add_u32 v7, v8, 16, v7
  v_lshrrev_b32 v6, 1, v6
  v_lshl_or_b32 v6, v8, 1, v6
  v_and_b32 v8, 1, v1
  v_lshl_add_u32 v7, v8, 4, v7
  v_bfe_u32 v8, v1, 1, 1
  v_lshl_add_u32 v7, v8, 3, v7
  v_xor_b32 v8, 0, v6
  v_lshl_add_u32 v10, v8, 5, v7
  v_xor_b32 v8, 1, v6
  v_lshl_add_u32 v11, v8, 5, v7
  v_xor_b32 v8, 2, v6
  v_lshl_add_u32 v12, v8, 5, v7
  v_xor_b32 v8, 3, v6
  v_lshl_add_u32 v13, v8, 5, v7
  s_mul_i32 s47, s57, 112
  s_lshr_b32 s48, s44, 4
  s_add_u32 s47, s47, s48
  s_lshl_b32 s47, s47, 10
  v_add_u32 v4, s47, v5
  s_barrier
  s_add_u32 m0, s43, 8192
  s_add_u32 s42, s42, 200704
  buffer_load_dwordx4 v2, s[8:11], s42 offen lds
  s_add_u32 m0, s43, 9216
  s_add_u32 s42, s42, 28672
  buffer_load_dwordx4 v2, s[8:11], s42 offen lds
  buffer_load_dwordx4 a[16:19], v3, s[12:15], s46 offen offset:0
  buffer_load_dwordx4 a[20:23], v3, s[12:15], s46 offen offset:1024
  buffer_load_dwordx4 a[24:27], v3, s[12:15], s46 offen offset:2048
  buffer_load_dwordx4 a[28:31], v3, s[12:15], s46 offen offset:3072
  s_add_u32 s46, s46, 4096
  v_and_b32 v6, 3, v1
  v_bfe_u32 v7, v1, 2, 1
  v_lshl_add_u32 v6, v7, 3, v6
  v_bfe_u32 v7, v1, 3, 1
  v_lshl_add_u32 v6, v7, 2, v6
  v_add_u32 v6, s44, v6
  v_bfe_u32 v7, v1, 4, 1
  v_mul_u32_u24 v7, 1792, v7
  v_add_u32 v6, v6, v7
  v_lshlrev_b32 v113, 4, v6
  v_lshrrev_b32 v7, 5, v1
  v_lshl_or_b32 v113, v7, 30, v113
  v_and_b32 v6, 31, v1
  s_lshl_b32 s47, s57, 5
  v_add_u32 v6, s47, v6
  v_lshlrev_b32 v115, 3, v6
  v_lshlrev_b32 v114, 4, v6
  v_lshl_or_b32 v114, v7, 30, v114
  v_lshrrev_b32 v5, 3, v1
  v_lshrrev_b32 v6, 1, v5
  v_lshrrev_b32 v7, 2, v1
  v_xor_b32 v6, v6, v7
  v_and_b32 v6, 1, v6
  v_lshlrev_b32 v6, 6, v6
  v_and_b32 v7, 3, v1
  v_lshl_add_u32 v6, v7, 4, v6
  v_lshl_add_u32 v124, v5, 10, v6
  s_mul_i32 s55, s53, 458752
  s_lshl_b32 s47, s54, 13
  s_add_u32 s55, s55, s47
  s_lshl_b32 s47, s51, 7
  s_add_u32 s55, s55, s47
  s_lshl_b32 s56, s53, 11
  s_lshl_b32 s47, s54, 10
  s_add_u32 s56, s56, s47
  s_waitcnt vmcnt(6)
  s_barrier
  ds_read_b64_tr_b16 v[16:17], v10 offset:0
  ds_read_b64_tr_b16 v[18:19], v10 offset:512
  ds_read_b64_tr_b16 v[20:21], v11 offset:0
  ds_read_b64_tr_b16 v[22:23], v11 offset:512
  ds_read_b64_tr_b16 v[24:25], v12 offset:0
  ds_read_b64_tr_b16 v[26:27], v12 offset:512
  ds_read_b64_tr_b16 v[28:29], v13 offset:0
  ds_read_b64_tr_b16 v[30:31], v13 offset:512
  s_waitcnt lgkmcnt(6)
  v_mfma_f32_32x32x16_bf16 v[48:63], v[16:19], a[0:3], 0
  ds_read_b64_tr_b16 v[32:33], v10 offset:2048
  ds_read_b64_tr_b16 v[34:35], v10 offset:2560
  s_waitcnt lgkmcnt(6)
  v_mfma_f32_32x32x16_bf16 v[64:79], v[20:23], a[0:3], 0
  ds_read_b64_tr_b16 v[36:37], v11 offset:2048
  ds_read_b64_tr_b16 v[38:39], v11 offset:2560
  s_add_u32 m0, s43, 16384
  s_add_u32 s42, s42, 200704
  buffer_load_dwordx4 v2, s[8:11], s42 offen lds
  s_waitcnt lgkmcnt(6)
  v_mfma_f32_32x32x16_bf16 v[80:95], v[24:27], a[0:3], 0
  ds_read_b64_tr_b16 v[40:41], v12 offset:2048
  ds_read_b64_tr_b16 v[42:43], v12 offset:2560
  s_waitcnt lgkmcnt(6)
  v_mfma_f32_32x32x16_bf16 v[96:111], v[28:31], a[0:3], 0
  ds_read_b64_tr_b16 v[44:45], v13 offset:2048
  ds_read_b64_tr_b16 v[46:47], v13 offset:2560
  s_add_u32 m0, s43, 17408
  s_add_u32 s42, s42, 28672
  buffer_load_dwordx4 v2, s[8:11], s42 offen lds
  s_waitcnt lgkmcnt(6)
  v_mfma_f32_32x32x16_bf16 v[48:63], v[32:35], a[4:7], v[48:63]
  ds_read_b64_tr_b16 v[16:17], v10 offset:4096
  ds_read_b64_tr_b16 v[18:19], v10 offset:4608
  s_waitcnt lgkmcnt(6)
  v_mfma_f32_32x32x16_bf16 v[64:79], v[36:39], a[4:7], v[64:79]
  ds_read_b64_tr_b16 v[20:21], v11 offset:4096
  ds_read_b64_tr_b16 v[22:23], v11 offset:4608
  buffer_load_dwordx4 a[32:35], v3, s[12:15], s46 offen offset:0
  s_waitcnt lgkmcnt(6)
  v_mfma_f32_32x32x16_bf16 v[80:95], v[40:43], a[4:7], v[80:95]
  ds_read_b64_tr_b16 v[24:25], v12 offset:4096
  ds_read_b64_tr_b16 v[26:27], v12 offset:4608
  s_waitcnt lgkmcnt(6)
  v_mfma_f32_32x32x16_bf16 v[96:111], v[44:47], a[4:7], v[96:111]
  ds_read_b64_tr_b16 v[28:29], v13 offset:4096
  ds_read_b64_tr_b16 v[30:31], v13 offset:4608
  buffer_load_dwordx4 a[36:39], v3, s[12:15], s46 offen offset:1024
  s_waitcnt lgkmcnt(6)
  v_mfma_f32_32x32x16_bf16 v[48:63], v[16:19], a[8:11], v[48:63]
  ds_read_b64_tr_b16 v[32:33], v10 offset:6144
  ds_read_b64_tr_b16 v[34:35], v10 offset:6656
  s_waitcnt lgkmcnt(6)
  v_mfma_f32_32x32x16_bf16 v[64:79], v[20:23], a[8:11], v[64:79]
  ds_read_b64_tr_b16 v[36:37], v11 offset:6144
  ds_read_b64_tr_b16 v[38:39], v11 offset:6656
  buffer_load_dwordx4 a[40:43], v3, s[12:15], s46 offen offset:2048
  s_waitcnt lgkmcnt(6)
  v_mfma_f32_32x32x16_bf16 v[80:95], v[24:27], a[8:11], v[80:95]
  ds_read_b64_tr_b16 v[40:41], v12 offset:6144
  ds_read_b64_tr_b16 v[42:43], v12 offset:6656
  s_waitcnt lgkmcnt(6)
  v_mfma_f32_32x32x16_bf16 v[96:111], v[28:31], a[8:11], v[96:111]
  ds_read_b64_tr_b16 v[44:45], v13 offset:6144
  ds_read_b64_tr_b16 v[46:47], v13 offset:6656
  buffer_load_dwordx4 a[44:47], v3, s[12:15], s46 offen offset:3072
  s_add_u32 s46, s46, 4096
  s_waitcnt vmcnt(6)
  s_barrier
  s_waitcnt lgkmcnt(6)
  v_mfma_f32_32x32x16_bf16 v[48:63], v[32:35], a[12:15], v[48:63]
  ds_read_b64_tr_b16 v[16:17], v10 offset:8192
  ds_read_b64_tr_b16 v[18:19], v10 offset:8704
  s_waitcnt lgkmcnt(6)
  v_mfma_f32_32x32x16_bf16 v[64:79], v[36:39], a[12:15], v[64:79]
  ds_read_b64_tr_b16 v[20:21], v11 offset:8192
  ds_read_b64_tr_b16 v[22:23], v11 offset:8704
  s_add_u32 m0, s43, 24576
  s_add_u32 s42, s42, 200704
  buffer_load_dwordx4 v2, s[8:11], s42 offen lds
  s_waitcnt lgkmcnt(6)
  v_mfma_f32_32x32x16_bf16 v[80:95], v[40:43], a[12:15], v[80:95]
  ds_read_b64_tr_b16 v[24:25], v12 offset:8192
  ds_read_b64_tr_b16 v[26:27], v12 offset:8704
  s_waitcnt lgkmcnt(6)
  v_mfma_f32_32x32x16_bf16 v[96:111], v[44:47], a[12:15], v[96:111]
  ds_read_b64_tr_b16 v[28:29], v13 offset:8192
  ds_read_b64_tr_b16 v[30:31], v13 offset:8704
  s_add_u32 m0, s43, 25600
  s_add_u32 s42, s42, 28672
  buffer_load_dwordx4 v2, s[8:11], s42 offen lds
  s_waitcnt lgkmcnt(6)
  v_mfma_f32_32x32x16_bf16 v[48:63], v[16:19], a[16:19], v[48:63]
  ds_read_b64_tr_b16 v[32:33], v10 offset:10240
  ds_read_b64_tr_b16 v[34:35], v10 offset:10752
  s_waitcnt lgkmcnt(6)
  v_mfma_f32_32x32x16_bf16 v[64:79], v[20:23], a[16:19], v[64:79]
  ds_read_b64_tr_b16 v[36:37], v11 offset:10240
  ds_read_b64_tr_b16 v[38:39], v11 offset:10752
  buffer_load_dwordx4 a[48:51], v3, s[12:15], s46 offen offset:0
  s_waitcnt lgkmcnt(6)
  v_mfma_f32_32x32x16_bf16 v[80:95], v[24:27], a[16:19], v[80:95]
  ds_read_b64_tr_b16 v[40:41], v12 offset:10240
  ds_read_b64_tr_b16 v[42:43], v12 offset:10752
  s_waitcnt lgkmcnt(6)
  v_mfma_f32_32x32x16_bf16 v[96:111], v[28:31], a[16:19], v[96:111]
  ds_read_b64_tr_b16 v[44:45], v13 offset:10240
  ds_read_b64_tr_b16 v[46:47], v13 offset:10752
  buffer_load_dwordx4 a[52:55], v3, s[12:15], s46 offen offset:1024
  s_waitcnt lgkmcnt(6)
  v_mfma_f32_32x32x16_bf16 v[48:63], v[32:35], a[20:23], v[48:63]
  ds_read_b64_tr_b16 v[16:17], v10 offset:12288
  ds_read_b64_tr_b16 v[18:19], v10 offset:12800
  s_waitcnt lgkmcnt(6)
  v_mfma_f32_32x32x16_bf16 v[64:79], v[36:39], a[20:23], v[64:79]
  ds_read_b64_tr_b16 v[20:21], v11 offset:12288
  ds_read_b64_tr_b16 v[22:23], v11 offset:12800
  buffer_load_dwordx4 a[56:59], v3, s[12:15], s46 offen offset:2048
  s_waitcnt lgkmcnt(6)
  v_mfma_f32_32x32x16_bf16 v[80:95], v[40:43], a[20:23], v[80:95]
  ds_read_b64_tr_b16 v[24:25], v12 offset:12288
  ds_read_b64_tr_b16 v[26:27], v12 offset:12800
  s_waitcnt lgkmcnt(6)
  v_mfma_f32_32x32x16_bf16 v[96:111], v[44:47], a[20:23], v[96:111]
  ds_read_b64_tr_b16 v[28:29], v13 offset:12288
  ds_read_b64_tr_b16 v[30:31], v13 offset:12800
  buffer_load_dwordx4 a[60:63], v3, s[12:15], s46 offen offset:3072
  s_add_u32 s46, s46, 4096
  s_waitcnt lgkmcnt(6)
  v_mfma_f32_32x32x16_bf16 v[48:63], v[16:19], a[24:27], v[48:63]
  ds_read_b64_tr_b16 v[32:33], v10 offset:14336
  ds_read_b64_tr_b16 v[34:35], v10 offset:14848
  s_waitcnt lgkmcnt(6)
  v_mfma_f32_32x32x16_bf16 v[64:79], v[20:23], a[24:27], v[64:79]
  ds_read_b64_tr_b16 v[36:37], v11 offset:14336
  ds_read_b64_tr_b16 v[38:39], v11 offset:14848
  s_add_u32 m0, s43, 32768
  s_add_u32 s42, s42, 200704
  buffer_load_dwordx4 v2, s[8:11], s42 offen lds
  s_waitcnt lgkmcnt(6)
  v_mfma_f32_32x32x16_bf16 v[80:95], v[24:27], a[24:27], v[80:95]
  ds_read_b64_tr_b16 v[40:41], v12 offset:14336
  ds_read_b64_tr_b16 v[42:43], v12 offset:14848
  s_waitcnt lgkmcnt(6)
  v_mfma_f32_32x32x16_bf16 v[96:111], v[28:31], a[24:27], v[96:111]
  ds_read_b64_tr_b16 v[44:45], v13 offset:14336
  ds_read_b64_tr_b16 v[46:47], v13 offset:14848
  s_add_u32 m0, s43, 33792
  s_add_u32 s42, s42, 28672
  buffer_load_dwordx4 v2, s[8:11], s42 offen lds
  s_waitcnt vmcnt(8)
  s_barrier
  s_waitcnt lgkmcnt(6)
  v_mfma_f32_32x32x16_bf16 v[48:63], v[32:35], a[28:31], v[48:63]
  ds_read_b64_tr_b16 v[16:17], v10 offset:16384
  ds_read_b64_tr_b16 v[18:19], v10 offset:16896
  s_waitcnt lgkmcnt(6)
  v_mfma_f32_32x32x16_bf16 v[64:79], v[36:39], a[28:31], v[64:79]
  ds_read_b64_tr_b16 v[20:21], v11 offset:16384
  ds_read_b64_tr_b16 v[22:23], v11 offset:16896
  buffer_load_dwordx4 a[64:67], v3, s[12:15], s46 offen offset:0
  s_waitcnt lgkmcnt(6)
  v_mfma_f32_32x32x16_bf16 v[80:95], v[40:43], a[28:31], v[80:95]
  ds_read_b64_tr_b16 v[24:25], v12 offset:16384
  ds_read_b64_tr_b16 v[26:27], v12 offset:16896
  s_waitcnt lgkmcnt(6)
  v_mfma_f32_32x32x16_bf16 v[96:111], v[44:47], a[28:31], v[96:111]
  ds_read_b64_tr_b16 v[28:29], v13 offset:16384
  ds_read_b64_tr_b16 v[30:31], v13 offset:16896
  buffer_load_dwordx4 a[68:71], v3, s[12:15], s46 offen offset:1024
  s_waitcnt lgkmcnt(6)
  v_mfma_f32_32x32x16_bf16 v[48:63], v[16:19], a[32:35], v[48:63]
  ds_read_b64_tr_b16 v[32:33], v10 offset:18432
  ds_read_b64_tr_b16 v[34:35], v10 offset:18944
  s_waitcnt lgkmcnt(6)
  v_mfma_f32_32x32x16_bf16 v[64:79], v[20:23], a[32:35], v[64:79]
  ds_read_b64_tr_b16 v[36:37], v11 offset:18432
  ds_read_b64_tr_b16 v[38:39], v11 offset:18944
  buffer_load_dwordx4 a[72:75], v3, s[12:15], s46 offen offset:2048
  s_waitcnt lgkmcnt(6)
  v_mfma_f32_32x32x16_bf16 v[80:95], v[24:27], a[32:35], v[80:95]
  ds_read_b64_tr_b16 v[40:41], v12 offset:18432
  ds_read_b64_tr_b16 v[42:43], v12 offset:18944
  s_waitcnt lgkmcnt(6)
  v_mfma_f32_32x32x16_bf16 v[96:111], v[28:31], a[32:35], v[96:111]
  ds_read_b64_tr_b16 v[44:45], v13 offset:18432
  ds_read_b64_tr_b16 v[46:47], v13 offset:18944
  buffer_load_dwordx4 a[76:79], v3, s[12:15], s46 offen offset:3072
  s_add_u32 s46, s46, 4096
  s_waitcnt lgkmcnt(6)
  v_mfma_f32_32x32x16_bf16 v[48:63], v[32:35], a[36:39], v[48:63]
  ds_read_b64_tr_b16 v[16:17], v10 offset:20480
  ds_read_b64_tr_b16 v[18:19], v10 offset:20992
  s_waitcnt lgkmcnt(6)
  v_mfma_f32_32x32x16_bf16 v[64:79], v[36:39], a[36:39], v[64:79]
  ds_read_b64_tr_b16 v[20:21], v11 offset:20480
  ds_read_b64_tr_b16 v[22:23], v11 offset:20992
  s_add_u32 m0, s43, 40960
  s_add_u32 s42, s42, 200704
  buffer_load_dwordx4 v2, s[8:11], s42 offen lds
  s_waitcnt lgkmcnt(6)
  v_mfma_f32_32x32x16_bf16 v[80:95], v[40:43], a[36:39], v[80:95]
  ds_read_b64_tr_b16 v[24:25], v12 offset:20480
  ds_read_b64_tr_b16 v[26:27], v12 offset:20992
  s_waitcnt lgkmcnt(6)
  v_mfma_f32_32x32x16_bf16 v[96:111], v[44:47], a[36:39], v[96:111]
  ds_read_b64_tr_b16 v[28:29], v13 offset:20480
  ds_read_b64_tr_b16 v[30:31], v13 offset:20992
  s_add_u32 m0, s43, 41984
  s_add_u32 s42, s42, 28672
  buffer_load_dwordx4 v2, s[8:11], s42 offen lds
  s_waitcnt lgkmcnt(6)
  v_mfma_f32_32x32x16_bf16 v[48:63], v[16:19], a[40:43], v[48:63]
  ds_read_b64_tr_b16 v[32:33], v10 offset:22528
  ds_read_b64_tr_b16 v[34:35], v10 offset:23040
  s_waitcnt lgkmcnt(6)
  v_mfma_f32_32x32x16_bf16 v[64:79], v[20:23], a[40:43], v[64:79]
  ds_read_b64_tr_b16 v[36:37], v11 offset:22528
  ds_read_b64_tr_b16 v[38:39], v11 offset:23040
  buffer_load_dwordx4 a[80:83], v3, s[12:15], s46 offen offset:0
  s_waitcnt lgkmcnt(6)
  v_mfma_f32_32x32x16_bf16 v[80:95], v[24:27], a[40:43], v[80:95]
  ds_read_b64_tr_b16 v[40:41], v12 offset:22528
  ds_read_b64_tr_b16 v[42:43], v12 offset:23040
  s_waitcnt lgkmcnt(6)
  v_mfma_f32_32x32x16_bf16 v[96:111], v[28:31], a[40:43], v[96:111]
  ds_read_b64_tr_b16 v[44:45], v13 offset:22528
  ds_read_b64_tr_b16 v[46:47], v13 offset:23040
  buffer_load_dwordx4 a[84:87], v3, s[12:15], s46 offen offset:1024
  s_waitcnt vmcnt(10)
  s_barrier
  s_waitcnt lgkmcnt(6)
  v_mfma_f32_32x32x16_bf16 v[48:63], v[32:35], a[44:47], v[48:63]
  ds_read_b64_tr_b16 v[16:17], v10 offset:24576
  ds_read_b64_tr_b16 v[18:19], v10 offset:25088
  s_waitcnt lgkmcnt(6)
  v_mfma_f32_32x32x16_bf16 v[64:79], v[36:39], a[44:47], v[64:79]
  ds_read_b64_tr_b16 v[20:21], v11 offset:24576
  ds_read_b64_tr_b16 v[22:23], v11 offset:25088
  buffer_load_dwordx4 a[88:91], v3, s[12:15], s46 offen offset:2048
  s_waitcnt lgkmcnt(6)
  v_mfma_f32_32x32x16_bf16 v[80:95], v[40:43], a[44:47], v[80:95]
  ds_read_b64_tr_b16 v[24:25], v12 offset:24576
  ds_read_b64_tr_b16 v[26:27], v12 offset:25088
  s_waitcnt lgkmcnt(6)
  v_mfma_f32_32x32x16_bf16 v[96:111], v[44:47], a[44:47], v[96:111]
  ds_read_b64_tr_b16 v[28:29], v13 offset:24576
  ds_read_b64_tr_b16 v[30:31], v13 offset:25088
  buffer_load_dwordx4 a[92:95], v3, s[12:15], s46 offen offset:3072
  s_add_u32 s46, s46, 4096
  s_waitcnt lgkmcnt(6)
  v_mfma_f32_32x32x16_bf16 v[48:63], v[16:19], a[48:51], v[48:63]
  ds_read_b64_tr_b16 v[32:33], v10 offset:26624
  ds_read_b64_tr_b16 v[34:35], v10 offset:27136
  s_waitcnt lgkmcnt(6)
  v_mfma_f32_32x32x16_bf16 v[64:79], v[20:23], a[48:51], v[64:79]
  ds_read_b64_tr_b16 v[36:37], v11 offset:26624
  ds_read_b64_tr_b16 v[38:39], v11 offset:27136
  s_add_u32 m0, s43, 49152
  s_add_u32 s42, s42, 200704
  buffer_load_dwordx4 v2, s[8:11], s42 offen lds
  s_waitcnt lgkmcnt(6)
  v_mfma_f32_32x32x16_bf16 v[80:95], v[24:27], a[48:51], v[80:95]
  ds_read_b64_tr_b16 v[40:41], v12 offset:26624
  ds_read_b64_tr_b16 v[42:43], v12 offset:27136
  s_waitcnt lgkmcnt(6)
  v_mfma_f32_32x32x16_bf16 v[96:111], v[28:31], a[48:51], v[96:111]
  ds_read_b64_tr_b16 v[44:45], v13 offset:26624
  ds_read_b64_tr_b16 v[46:47], v13 offset:27136
  s_add_u32 m0, s43, 50176
  s_add_u32 s42, s42, 28672
  buffer_load_dwordx4 v2, s[8:11], s42 offen lds
  s_waitcnt lgkmcnt(6)
  v_mfma_f32_32x32x16_bf16 v[48:63], v[32:35], a[52:55], v[48:63]
  ds_read_b64_tr_b16 v[16:17], v10 offset:28672
  ds_read_b64_tr_b16 v[18:19], v10 offset:29184
  s_waitcnt lgkmcnt(6)
  v_mfma_f32_32x32x16_bf16 v[64:79], v[36:39], a[52:55], v[64:79]
  ds_read_b64_tr_b16 v[20:21], v11 offset:28672
  ds_read_b64_tr_b16 v[22:23], v11 offset:29184
  buffer_load_dwordx4 a[96:99], v3, s[12:15], s46 offen offset:0
  s_waitcnt lgkmcnt(6)
  v_mfma_f32_32x32x16_bf16 v[80:95], v[40:43], a[52:55], v[80:95]
  ds_read_b64_tr_b16 v[24:25], v12 offset:28672
  ds_read_b64_tr_b16 v[26:27], v12 offset:29184
  s_waitcnt lgkmcnt(6)
  v_mfma_f32_32x32x16_bf16 v[96:111], v[44:47], a[52:55], v[96:111]
  ds_read_b64_tr_b16 v[28:29], v13 offset:28672
  ds_read_b64_tr_b16 v[30:31], v13 offset:29184
  buffer_load_dwordx4 a[100:103], v3, s[12:15], s46 offen offset:1024
  s_waitcnt lgkmcnt(6)
  v_mfma_f32_32x32x16_bf16 v[48:63], v[16:19], a[56:59], v[48:63]
  ds_read_b64_tr_b16 v[32:33], v10 offset:30720
  ds_read_b64_tr_b16 v[34:35], v10 offset:31232
  s_waitcnt lgkmcnt(6)
  v_mfma_f32_32x32x16_bf16 v[64:79], v[20:23], a[56:59], v[64:79]
  ds_read_b64_tr_b16 v[36:37], v11 offset:30720
  ds_read_b64_tr_b16 v[38:39], v11 offset:31232
  buffer_load_dwordx4 a[104:107], v3, s[12:15], s46 offen offset:2048
  s_waitcnt lgkmcnt(6)
  v_mfma_f32_32x32x16_bf16 v[80:95], v[24:27], a[56:59], v[80:95]
  ds_read_b64_tr_b16 v[40:41], v12 offset:30720
  ds_read_b64_tr_b16 v[42:43], v12 offset:31232
  s_waitcnt lgkmcnt(6)
  v_mfma_f32_32x32x16_bf16 v[96:111], v[28:31], a[56:59], v[96:111]
  ds_read_b64_tr_b16 v[44:45], v13 offset:30720
  ds_read_b64_tr_b16 v[46:47], v13 offset:31232
  buffer_load_dwordx4 a[108:111], v3, s[12:15], s46 offen offset:3072
  s_add_u32 s46, s46, 4096
  s_waitcnt vmcnt(12)
  s_barrier
  s_waitcnt lgkmcnt(6)
  v_mfma_f32_32x32x16_bf16 v[48:63], v[32:35], a[60:63], v[48:63]
  ds_read_b64_tr_b16 v[16:17], v10 offset:32768
  ds_read_b64_tr_b16 v[18:19], v10 offset:33280
  s_waitcnt lgkmcnt(6)
  v_mfma_f32_32x32x16_bf16 v[64:79], v[36:39], a[60:63], v[64:79]
  ds_read_b64_tr_b16 v[20:21], v11 offset:32768
  ds_read_b64_tr_b16 v[22:23], v11 offset:33280
  s_add_u32 m0, s43, 57344
  s_add_u32 s42, s42, 200704
  buffer_load_dwordx4 v2, s[8:11], s42 offen lds
  s_waitcnt lgkmcnt(6)
  v_mfma_f32_32x32x16_bf16 v[80:95], v[40:43], a[60:63], v[80:95]
  ds_read_b64_tr_b16 v[24:25], v12 offset:32768
  ds_read_b64_tr_b16 v[26:27], v12 offset:33280
  s_waitcnt lgkmcnt(6)
  v_mfma_f32_32x32x16_bf16 v[96:111], v[44:47], a[60:63], v[96:111]
  ds_read_b64_tr_b16 v[28:29], v13 offset:32768
  ds_read_b64_tr_b16 v[30:31], v13 offset:33280
  s_add_u32 m0, s43, 58368
  s_add_u32 s42, s42, 28672
  buffer_load_dwordx4 v2, s[8:11], s42 offen lds
  s_waitcnt lgkmcnt(6)
  v_mfma_f32_32x32x16_bf16 v[48:63], v[16:19], a[64:67], v[48:63]
  ds_read_b64_tr_b16 v[32:33], v10 offset:34816
  ds_read_b64_tr_b16 v[34:35], v10 offset:35328
  s_waitcnt lgkmcnt(6)
  v_mfma_f32_32x32x16_bf16 v[64:79], v[20:23], a[64:67], v[64:79]
  ds_read_b64_tr_b16 v[36:37], v11 offset:34816
  ds_read_b64_tr_b16 v[38:39], v11 offset:35328
  buffer_load_dwordx4 a[112:115], v3, s[12:15], s46 offen offset:0
  s_waitcnt lgkmcnt(6)
  v_mfma_f32_32x32x16_bf16 v[80:95], v[24:27], a[64:67], v[80:95]
  ds_read_b64_tr_b16 v[40:41], v12 offset:34816
  ds_read_b64_tr_b16 v[42:43], v12 offset:35328
  s_waitcnt lgkmcnt(6)
  v_mfma_f32_32x32x16_bf16 v[96:111], v[28:31], a[64:67], v[96:111]
  ds_read_b64_tr_b16 v[44:45], v13 offset:34816
  ds_read_b64_tr_b16 v[46:47], v13 offset:35328
  buffer_load_dwordx4 a[116:119], v3, s[12:15], s46 offen offset:1024
  s_waitcnt lgkmcnt(6)
  v_mfma_f32_32x32x16_bf16 v[48:63], v[32:35], a[68:71], v[48:63]
  ds_read_b64_tr_b16 v[16:17], v10 offset:36864
  ds_read_b64_tr_b16 v[18:19], v10 offset:37376
  s_waitcnt lgkmcnt(6)
  v_mfma_f32_32x32x16_bf16 v[64:79], v[36:39], a[68:71], v[64:79]
  ds_read_b64_tr_b16 v[20:21], v11 offset:36864
  ds_read_b64_tr_b16 v[22:23], v11 offset:37376
  buffer_load_dwordx4 a[120:123], v3, s[12:15], s46 offen offset:2048
  s_waitcnt lgkmcnt(6)
  v_mfma_f32_32x32x16_bf16 v[80:95], v[40:43], a[68:71], v[80:95]
  ds_read_b64_tr_b16 v[24:25], v12 offset:36864
  ds_read_b64_tr_b16 v[26:27], v12 offset:37376
  s_waitcnt lgkmcnt(6)
  v_mfma_f32_32x32x16_bf16 v[96:111], v[44:47], a[68:71], v[96:111]
  ds_read_b64_tr_b16 v[28:29], v13 offset:36864
  ds_read_b64_tr_b16 v[30:31], v13 offset:37376
  buffer_load_dwordx4 a[124:127], v3, s[12:15], s46 offen offset:3072
  s_waitcnt lgkmcnt(6)
  v_mfma_f32_32x32x16_bf16 v[48:63], v[16:19], a[72:75], v[48:63]
  ds_read_b64_tr_b16 v[32:33], v10 offset:38912
  ds_read_b64_tr_b16 v[34:35], v10 offset:39424
  s_waitcnt lgkmcnt(6)
  v_mfma_f32_32x32x16_bf16 v[64:79], v[20:23], a[72:75], v[64:79]
  ds_read_b64_tr_b16 v[36:37], v11 offset:38912
  ds_read_b64_tr_b16 v[38:39], v11 offset:39424
  s_waitcnt lgkmcnt(6)
  v_mfma_f32_32x32x16_bf16 v[80:95], v[24:27], a[72:75], v[80:95]
  ds_read_b64_tr_b16 v[40:41], v12 offset:38912
  ds_read_b64_tr_b16 v[42:43], v12 offset:39424
  s_add_u32 m0, s56, 131072
  s_nop 0
  buffer_load_dwordx4 v124, s[20:23], s55 offen lds
  s_waitcnt lgkmcnt(6)
  v_mfma_f32_32x32x16_bf16 v[96:111], v[28:31], a[72:75], v[96:111]
  ds_read_b64_tr_b16 v[44:45], v13 offset:38912
  ds_read_b64_tr_b16 v[46:47], v13 offset:39424
  s_waitcnt vmcnt(13)
  s_barrier
  s_waitcnt lgkmcnt(6)
  v_mfma_f32_32x32x16_bf16 v[48:63], v[32:35], a[76:79], v[48:63]
  ds_read_b64_tr_b16 v[16:17], v10 offset:40960
  ds_read_b64_tr_b16 v[18:19], v10 offset:41472
  s_waitcnt lgkmcnt(6)
  v_mfma_f32_32x32x16_bf16 v[64:79], v[36:39], a[76:79], v[64:79]
  ds_read_b64_tr_b16 v[20:21], v11 offset:40960
  ds_read_b64_tr_b16 v[22:23], v11 offset:41472
  s_add_u32 m0, s56, 139264
  s_add_u32 s55, s55, 16384
  buffer_load_dwordx4 v124, s[20:23], s55 offen lds
  s_waitcnt lgkmcnt(6)
  v_mfma_f32_32x32x16_bf16 v[80:95], v[40:43], a[76:79], v[80:95]
  ds_read_b64_tr_b16 v[24:25], v12 offset:40960
  ds_read_b64_tr_b16 v[26:27], v12 offset:41472
  s_waitcnt lgkmcnt(6)
  v_mfma_f32_32x32x16_bf16 v[96:111], v[44:47], a[76:79], v[96:111]
  ds_read_b64_tr_b16 v[28:29], v13 offset:40960
  ds_read_b64_tr_b16 v[30:31], v13 offset:41472
  s_waitcnt lgkmcnt(6)
  v_mfma_f32_32x32x16_bf16 v[48:63], v[16:19], a[80:83], v[48:63]
  ds_read_b64_tr_b16 v[32:33], v10 offset:43008
  ds_read_b64_tr_b16 v[34:35], v10 offset:43520
  s_add_u32 m0, s56, 147456
  s_add_u32 s55, s55, 16384
  buffer_load_dwordx4 v124, s[20:23], s55 offen lds
  s_waitcnt lgkmcnt(6)
  v_mfma_f32_32x32x16_bf16 v[64:79], v[20:23], a[80:83], v[64:79]
  ds_read_b64_tr_b16 v[36:37], v11 offset:43008
  ds_read_b64_tr_b16 v[38:39], v11 offset:43520
  s_waitcnt lgkmcnt(6)
  v_mfma_f32_32x32x16_bf16 v[80:95], v[24:27], a[80:83], v[80:95]
  ds_read_b64_tr_b16 v[40:41], v12 offset:43008
  ds_read_b64_tr_b16 v[42:43], v12 offset:43520
  s_waitcnt lgkmcnt(6)
  v_mfma_f32_32x32x16_bf16 v[96:111], v[28:31], a[80:83], v[96:111]
  ds_read_b64_tr_b16 v[44:45], v13 offset:43008
  ds_read_b64_tr_b16 v[46:47], v13 offset:43520
  s_add_u32 m0, s56, 155648
  s_add_u32 s55, s55, 16384
  buffer_load_dwordx4 v124, s[20:23], s55 offen lds
  s_waitcnt lgkmcnt(6)
  v_mfma_f32_32x32x16_bf16 v[48:63], v[32:35], a[84:87], v[48:63]
  ds_read_b64_tr_b16 v[16:17], v10 offset:45056
  ds_read_b64_tr_b16 v[18:19], v10 offset:45568
  s_waitcnt lgkmcnt(6)
  v_mfma_f32_32x32x16_bf16 v[64:79], v[36:39], a[84:87], v[64:79]
  ds_read_b64_tr_b16 v[20:21], v11 offset:45056
  ds_read_b64_tr_b16 v[22:23], v11 offset:45568
  s_waitcnt lgkmcnt(6)
  v_mfma_f32_32x32x16_bf16 v[80:95], v[40:43], a[84:87], v[80:95]
  ds_read_b64_tr_b16 v[24:25], v12 offset:45056
  ds_read_b64_tr_b16 v[26:27], v12 offset:45568
  s_add_u32 m0, s56, 0
  s_add_u32 s55, s55, 16384
  buffer_load_dwordx4 v124, s[20:23], s55 offen lds
  s_waitcnt lgkmcnt(6)
  v_mfma_f32_32x32x16_bf16 v[96:111], v[44:47], a[84:87], v[96:111]
  ds_read_b64_tr_b16 v[28:29], v13 offset:45056
  ds_read_b64_tr_b16 v[30:31], v13 offset:45568
  s_waitcnt lgkmcnt(6)
  v_mfma_f32_32x32x16_bf16 v[48:63], v[16:19], a[88:91], v[48:63]
  ds_read_b64_tr_b16 v[32:33], v10 offset:47104
  ds_read_b64_tr_b16 v[34:35], v10 offset:47616
  s_waitcnt lgkmcnt(6)
  v_mfma_f32_32x32x16_bf16 v[64:79], v[20:23], a[88:91], v[64:79]
  ds_read_b64_tr_b16 v[36:37], v11 offset:47104
  ds_read_b64_tr_b16 v[38:39], v11 offset:47616
  s_add_u32 m0, s56, 65536
  s_add_u32 s55, s55, 16384
  buffer_load_dwordx4 v124, s[20:23], s55 offen lds
  s_waitcnt lgkmcnt(6)
  v_mfma_f32_32x32x16_bf16 v[80:95], v[24:27], a[88:91], v[80:95]
  ds_read_b64_tr_b16 v[40:41], v12 offset:47104
  ds_read_b64_tr_b16 v[42:43], v12 offset:47616
  s_waitcnt lgkmcnt(6)
  v_mfma_f32_32x32x16_bf16 v[96:111], v[28:31], a[88:91], v[96:111]
  ds_read_b64_tr_b16 v[44:45], v13 offset:47104
  ds_read_b64_tr_b16 v[46:47], v13 offset:47616
  s_waitcnt vmcnt(12)
  s_barrier
  s_waitcnt lgkmcnt(6)
  v_mfma_f32_32x32x16_bf16 v[48:63], v[32:35], a[92:95], v[48:63]
  ds_read_b64_tr_b16 v[16:17], v10 offset:49152
  ds_read_b64_tr_b16 v[18:19], v10 offset:49664
  s_add_u32 m0, s56, 8192
  s_add_u32 s55, s55, 16384
  buffer_load_dwordx4 v124, s[20:23], s55 offen lds
  s_waitcnt lgkmcnt(6)
  v_mfma_f32_32x32x16_bf16 v[64:79], v[36:39], a[92:95], v[64:79]
  ds_read_b64_tr_b16 v[20:21], v11 offset:49152
  ds_read_b64_tr_b16 v[22:23], v11 offset:49664
  s_waitcnt lgkmcnt(6)
  v_mfma_f32_32x32x16_bf16 v[80:95], v[40:43], a[92:95], v[80:95]
  ds_read_b64_tr_b16 v[24:25], v12 offset:49152
  ds_read_b64_tr_b16 v[26:27], v12 offset:49664
  s_waitcnt lgkmcnt(6)
  v_mfma_f32_32x32x16_bf16 v[96:111], v[44:47], a[92:95], v[96:111]
  ds_read_b64_tr_b16 v[28:29], v13 offset:49152
  ds_read_b64_tr_b16 v[30:31], v13 offset:49664
  s_add_u32 m0, s56, 73728
  s_add_u32 s55, s55, 16384
  buffer_load_dwordx4 v124, s[20:23], s55 offen lds
  s_and_b32 s47, s2, 7
  s_lshl_b32 s47, s47, 8
  s_add_u32 s47, s47, 2048
  s_cmp_eq_u32 s40, 0
  s_cselect_b32 s47, s47, 0x4000
  v_mov_b32 v6, s47
  buffer_load_dword v116, v6, s[24:27], 0 offen sc1
  s_waitcnt lgkmcnt(6)
  v_mfma_f32_32x32x16_bf16 v[48:63], v[16:19], a[96:99], v[48:63]
  ds_read_b64_tr_b16 v[32:33], v10 offset:51200
  ds_read_b64_tr_b16 v[34:35], v10 offset:51712
  s_waitcnt lgkmcnt(6)
  v_mfma_f32_32x32x16_bf16 v[64:79], v[20:23], a[96:99], v[64:79]
  ds_read_b64_tr_b16 v[36:37], v11 offset:51200
  ds_read_b64_tr_b16 v[38:39], v11 offset:51712
  s_waitcnt lgkmcnt(6)
  v_mfma_f32_32x32x16_bf16 v[80:95], v[24:27], a[96:99], v[80:95]
  ds_read_b64_tr_b16 v[40:41], v12 offset:51200
  ds_read_b64_tr_b16 v[42:43], v12 offset:51712
  s_add_u32 m0, s56, 16384
  s_add_u32 s55, s55, 16384
  buffer_load_dwordx4 v124, s[20:23], s55 offen lds
  s_waitcnt lgkmcnt(6)
  v_mfma_f32_32x32x16_bf16 v[96:111], v[28:31], a[96:99], v[96:111]
  ds_read_b64_tr_b16 v[44:45], v13 offset:51200
  ds_read_b64_tr_b16 v[46:47], v13 offset:51712
  s_waitcnt lgkmcnt(6)
  v_mfma_f32_32x32x16_bf16 v[48:63], v[32:35], a[100:103], v[48:63]
  ds_read_b64_tr_b16 v[16:17], v10 offset:53248
  ds_read_b64_tr_b16 v[18:19], v10 offset:53760
  s_waitcnt lgkmcnt(6)
  v_mfma_f32_32x32x16_bf16 v[64:79], v[36:39], a[100:103], v[64:79]
  ds_read_b64_tr_b16 v[20:21], v11 offset:53248
  ds_read_b64_tr_b16 v[22:23], v11 offset:53760
  s_add_u32 m0, s56, 81920
  s_add_u32 s55, s55, 16384
  buffer_load_dwordx4 v124, s[20:23], s55 offen lds
  s_waitcnt lgkmcnt(6)
  v_mfma_f32_32x32x16_bf16 v[80:95], v[40:43], a[100:103], v[80:95]
  ds_read_b64_tr_b16 v[24:25], v12 offset:53248
  ds_read_b64_tr_b16 v[26:27], v12 offset:53760
  s_waitcnt lgkmcnt(6)
  v_mfma_f32_32x32x16_bf16 v[96:111], v[44:47], a[100:103], v[96:111]
  ds_read_b64_tr_b16 v[28:29], v13 offset:53248
  ds_read_b64_tr_b16 v[30:31], v13 offset:53760
  s_waitcnt lgkmcnt(6)
  v_mfma_f32_32x32x16_bf16 v[48:63], v[16:19], a[104:107], v[48:63]
  ds_read_b64_tr_b16 v[32:33], v10 offset:55296
  ds_read_b64_tr_b16 v[34:35], v10 offset:55808
  s_add_u32 m0, s56, 24576
  s_add_u32 s55, s55, 16384
  buffer_load_dwordx4 v124, s[20:23], s55 offen lds
  s_waitcnt lgkmcnt(6)
  v_mfma_f32_32x32x16_bf16 v[64:79], v[20:23], a[104:107], v[64:79]
  ds_read_b64_tr_b16 v[36:37], v11 offset:55296
  ds_read_b64_tr_b16 v[38:39], v11 offset:55808
  s_waitcnt lgkmcnt(6)
  v_mfma_f32_32x32x16_bf16 v[80:95], v[24:27], a[104:107], v[80:95]
  ds_read_b64_tr_b16 v[40:41], v12 offset:55296
  ds_read_b64_tr_b16 v[42:43], v12 offset:55808
  s_waitcnt lgkmcnt(6)
  v_mfma_f32_32x32x16_bf16 v[96:111], v[28:31], a[104:107], v[96:111]
  ds_read_b64_tr_b16 v[44:45], v13 offset:55296
  ds_read_b64_tr_b16 v[46:47], v13 offset:55808
  s_add_u32 m0, s56, 90112
  s_add_u32 s55, s55, 16384
  buffer_load_dwordx4 v124, s[20:23], s55 offen lds
  s_cmp_lg_u32 s40, 0
  s_cbranch_scc1 ffn_kernel_hok0
  s_waitcnt vmcnt(4)
  v_readfirstlane_b32 s47, v116
  s_mov_b32 s48, 200000
ffn_kernel_hchk0:
  s_cmp_ge_u32 s47, 32
  s_cbranch_scc1 ffn_kernel_hok0
  s_sleep 2
  buffer_load_dword v116, v6, s[24:27], 0 offen sc1
  s_waitcnt vmcnt(0)
  v_readfirstlane_b32 s47, v116
  s_sub_u32 s48, s48, 1
  s_cmp_lg_u32 s48, 0
  s_cbranch_scc1 ffn_kernel_hchk0
ffn_kernel_hok0:
  s_waitcnt vmcnt(13)
  s_barrier
  s_add_u32 s28, s34, 0x1010000
  s_addc_u32 s29, s35, 0
  s_mov_b32 s30, 0xe000
  s_mov_b32 s31, 0x20000
  buffer_load_dwordx4 a[0:3], v113, s[28:31], 0 offen offset:0 sc1
  buffer_load_dwordx4 a[4:7], v113, s[28:31], 0 offen offset:256 sc1
  buffer_load_dwordx4 a[8:11], v113, s[28:31], 0 offen offset:512 sc1
  buffer_load_dwordx4 a[12:15], v113, s[28:31], 0 offen offset:768 sc1
  s_add_u32 s12, s34, 0x1020000
  s_addc_u32 s13, s35, 0
  s_mov_b32 s14, 0x8000
  s_mov_b32 s15, 0x20000
  buffer_load_dwordx4 a[16:19], v114, s[12:15], 0 offen sc1
  s_add_u32 s8, s34, 0x1030000
  s_addc_u32 s9, s35, 0
  s_mov_b32 s10, 0x4000
  s_mov_b32 s11, 0x20000
  buffer_load_dwordx2 v[14:15], v115, s[8:11], 0 offen sc1
  s_lshr_b32 s47, s2, 3
  s_lshl_b32 s47, s47, 16
  v_lshlrev_b32 v7, 7, v0
  buffer_load_dword v112, v7, s[20:23], s47 offen
  s_waitcnt lgkmcnt(6)
  v_mfma_f32_32x32x16_bf16 v[48:63], v[32:35], a[108:111], v[48:63]
  ds_read_b64_tr_b16 v[16:17], v10 offset:57344
  ds_read_b64_tr_b16 v[18:19], v10 offset:57856
  s_waitcnt lgkmcnt(6)
  v_mfma_f32_32x32x16_bf16 v[64:79], v[36:39], a[108:111], v[64:79]
  ds_read_b64_tr_b16 v[20:21], v11 offset:57344
  ds_read_b64_tr_b16 v[22:23], v11 offset:57856
  s_waitcnt lgkmcnt(6)
  v_mfma_f32_32x32x16_bf16 v[80:95], v[40:43], a[108:111], v[80:95]
  ds_read_b64_tr_b16 v[24:25], v12 offset:57344
  ds_read_b64_tr_b16 v[26:27], v12 offset:57856
  s_add_u32 m0, s56, 32768
  s_add_u32 s55, s55, 16384
  buffer_load_dwordx4 v124, s[20:23], s55 offen lds
  s_waitcnt lgkmcnt(6)
  v_mfma_f32_32x32x16_bf16 v[96:111], v[44:47], a[108:111], v[96:111]
  ds_read_b64_tr_b16 v[28:29], v13 offset:57344
  ds_read_b64_tr_b16 v[30:31], v13 offset:57856
  s_waitcnt lgkmcnt(6)
  v_mfma_f32_32x32x16_bf16 v[48:63], v[16:19], a[112:115], v[48:63]
  ds_read_b64_tr_b16 v[32:33], v10 offset:59392
  ds_read_b64_tr_b16 v[34:35], v10 offset:59904
  s_waitcnt lgkmcnt(6)
  v_mfma_f32_32x32x16_bf16 v[64:79], v[20:23], a[112:115], v[64:79]
  ds_read_b64_tr_b16 v[36:37], v11 offset:59392
  ds_read_b64_tr_b16 v[38:39], v11 offset:59904
  s_add_u32 m0, s56, 98304
  s_add_u32 s55, s55, 16384
  buffer_load_dwordx4 v124, s[20:23], s55 offen lds
  s_waitcnt lgkmcnt(6)
  v_mfma_f32_32x32x16_bf16 v[80:95], v[24:27], a[112:115], v[80:95]
  ds_read_b64_tr_b16 v[40:41], v12 offset:59392
  ds_read_b64_tr_b16 v[42:43], v12 offset:59904
  s_waitcnt lgkmcnt(6)
  v_mfma_f32_32x32x16_bf16 v[96:111], v[28:31], a[112:115], v[96:111]
  ds_read_b64_tr_b16 v[44:45], v13 offset:59392
  ds_read_b64_tr_b16 v[46:47], v13 offset:59904
  s_waitcnt lgkmcnt(6)
  v_mfma_f32_32x32x16_bf16 v[48:63], v[32:35], a[116:119], v[48:63]
  ds_read_b64_tr_b16 v[16:17], v10 offset:61440
  ds_read_b64_tr_b16 v[18:19], v10 offset:61952
  s_add_u32 m0, s56, 40960
  s_add_u32 s55, s55, 16384
  buffer_load_dwordx4 v124, s[20:23], s55 offen lds
  s_waitcnt lgkmcnt(6)
  v_mfma_f32_32x32x16_bf16 v[64:79], v[36:39], a[116:119], v[64:79]
  ds_read_b64_tr_b16 v[20:21], v11 offset:61440
  ds_read_b64_tr_b16 v[22:23], v11 offset:61952
  s_waitcnt lgkmcnt(6)
  v_mfma_f32_32x32x16_bf16 v[80:95], v[40:43], a[116:119], v[80:95]
  ds_read_b64_tr_b16 v[24:25], v12 offset:61440
  ds_read_b64_tr_b16 v[26:27], v12 offset:61952
  s_waitcnt lgkmcnt(6)
  v_mfma_f32_32x32x16_bf16 v[96:111], v[44:47], a[116:119], v[96:111]
  ds_read_b64_tr_b16 v[28:29], v13 offset:61440
  ds_read_b64_tr_b16 v[30:31], v13 offset:61952
  s_add_u32 m0, s56, 106496
  s_add_u32 s55, s55, 16384
  buffer_load_dwordx4 v124, s[20:23], s55 offen lds
  s_waitcnt lgkmcnt(6)
  v_mfma_f32_32x32x16_bf16 v[48:63], v[16:19], a[120:123], v[48:63]
  ds_read_b64_tr_b16 v[32:33], v10 offset:63488
  ds_read_b64_tr_b16 v[34:35], v10 offset:64000
  s_waitcnt lgkmcnt(6)
  v_mfma_f32_32x32x16_bf16 v[64:79], v[20:23], a[120:123], v[64:79]
  ds_read_b64_tr_b16 v[36:37], v11 offset:63488
  ds_read_b64_tr_b16 v[38:39], v11 offset:64000
  s_waitcnt lgkmcnt(6)
  v_mfma_f32_32x32x16_bf16 v[80:95], v[24:27], a[120:123], v[80:95]
  ds_read_b64_tr_b16 v[40:41], v12 offset:63488
  ds_read_b64_tr_b16 v[42:43], v12 offset:64000
  s_waitcnt lgkmcnt(6)
  v_mfma_f32_32x32x16_bf16 v[96:111], v[28:31], a[120:123], v[96:111]
  ds_read_b64_tr_b16 v[44:45], v13 offset:63488
  ds_read_b64_tr_b16 v[46:47], v13 offset:64000
  s_waitcnt lgkmcnt(6)
  v_mfma_f32_32x32x16_bf16 v[48:63], v[32:35], a[124:127], v[48:63]
  s_waitcnt lgkmcnt(4)
  v_mfma_f32_32x32x16_bf16 v[64:79], v[36:39], a[124:127], v[64:79]
  s_waitcnt lgkmcnt(2)
  v_mfma_f32_32x32x16_bf16 v[80:95], v[40:43], a[124:127], v[80:95]
  s_waitcnt lgkmcnt(0)
  v_mfma_f32_32x32x16_bf16 v[96:111], v[44:47], a[124:127], v[96:111]
  s_waitcnt vmcnt(5)
  v_mfma_f32_32x32x16_bf16 v[48:63], a[0:3], a[16:19], v[48:63]
  v_mfma_f32_32x32x16_bf16 v[64:79], a[4:7], a[16:19], v[64:79]
  v_mfma_f32_32x32x16_bf16 v[80:95], a[8:11], a[16:19], v[80:95]
  v_mfma_f32_32x32x16_bf16 v[96:111], a[12:15], a[16:19], v[96:111]
  s_nop 8
  v_pk_mul_f32 v[16:17], v[48:49], v[14:15] op_sel_hi:[1,0]
  v_pk_mul_f32 v[18:19], v[50:51], v[14:15] op_sel_hi:[1,0]
  v_pk_mul_f32 v[20:21], v[52:53], v[14:15] op_sel_hi:[1,0]
  v_pk_mul_f32 v[22:23], v[54:55], v[14:15] op_sel_hi:[1,0]
  v_exp_f32 v16, v16
  v_exp_f32 v17, v17
  v_exp_f32 v18, v18
  v_exp_f32 v19, v19
  v_exp_f32 v20, v20
  v_exp_f32 v21, v21
  v_exp_f32 v22, v22
  v_exp_f32 v23, v23
  v_pk_mul_f32 v[56:57], v[48:49], v[56:57]
  v_pk_mul_f32 v[58:59], v[50:51], v[58:59]
  v_pk_mul_f32 v[60:61], v[52:53], v[60:61]
  v_pk_mul_f32 v[62:63], v[54:55], v[62:63]
  v_pk_fma_f32 v[16:17], v[16:17], v[14:15], v[14:15] op_sel:[0,1,1] op_sel_hi:[1,1,1]
  v_pk_fma_f32 v[18:19], v[18:19], v[14:15], v[14:15] op_sel:[0,1,1] op_sel_hi:[1,1,1]
  v_pk_fma_f32 v[20:21], v[20:21], v[14:15], v[14:15] op_sel:[0,1,1] op_sel_hi:[1,1,1]
  v_pk_fma_f32 v[22:23], v[22:23], v[14:15], v[14:15] op_sel:[0,1,1] op_sel_hi:[1,1,1]
  v_rcp_f32 v16, v16
  v_rcp_f32 v17, v17
  v_rcp_f32 v18, v18
  v_rcp_f32 v19, v19
  v_rcp_f32 v20, v20
  v_rcp_f32 v21, v21
  v_rcp_f32 v22, v22
  v_rcp_f32 v23, v23
  s_nop 0
  v_pk_mul_f32 v[56:57], v[56:57], v[16:17]
  v_pk_mul_f32 v[58:59], v[58:59], v[18:19]
  v_pk_mul_f32 v[60:61], v[60:61], v[20:21]
  v_pk_mul_f32 v[62:63], v[62:63], v[22:23]
  v_cvt_pk_bf16_f32 v24, v56, v57
  v_cvt_pk_bf16_f32 v25, v58, v59
  v_cvt_pk_bf16_f32 v26, v60, v61
  v_cvt_pk_bf16_f32 v27, v62, v63
  buffer_store_dwordx4 v[24:27], v4, s[16:19], 0 offen offset:0 sc1
  v_pk_mul_f32 v[32:33], v[64:65], v[14:15] op_sel_hi:[1,0]
  v_pk_mul_f32 v[34:35], v[66:67], v[14:15] op_sel_hi:[1,0]
  v_pk_mul_f32 v[36:37], v[68:69], v[14:15] op_sel_hi:[1,0]
  v_pk_mul_f32 v[38:39], v[70:71], v[14:15] op_sel_hi:[1,0]
  v_exp_f32 v32, v32
  v_exp_f32 v33, v33
  v_exp_f32 v34, v34
  v_exp_f32 v35, v35
  v_exp_f32 v36, v36
  v_exp_f32 v37, v37
  v_exp_f32 v38, v38
  v_exp_f32 v39, v39
  v_pk_mul_f32 v[72:73], v[64:65], v[72:73]
  v_pk_mul_f32 v[74:75], v[66:67], v[74:75]
  v_pk_mul_f32 v[76:77], v[68:69], v[76:77]
  v_pk_mul_f32 v[78:79], v[70:71], v[78:79]
  v_pk_fma_f32 v[32:33], v[32:33], v[14:15], v[14:15] op_sel:[0,1,1] op_sel_hi:[1,1,1]
  v_pk_fma_f32 v[34:35], v[34:35], v[14:15], v[14:15] op_sel:[0,1,1] op_sel_hi:[1,1,1]
  v_pk_fma_f32 v[36:37], v[36:37], v[14:15], v[14:15] op_sel:[0,1,1] op_sel_hi:[1,1,1]
  v_pk_fma_f32 v[38:39], v[38:39], v[14:15], v[14:15] op_sel:[0,1,1] op_sel_hi:[1,1,1]
  v_rcp_f32 v32, v32
  v_rcp_f32 v33, v33
  v_rcp_f32 v34, v34
  v_rcp_f32 v35, v35
  v_rcp_f32 v36, v36
  v_rcp_f32 v37, v37
  v_rcp_f32 v38, v38
  v_rcp_f32 v39, v39
  s_nop 0
  v_pk_mul_f32 v[72:73], v[72:73], v[32:33]
  v_pk_mul_f32 v[74:75], v[74:75], v[34:35]
  v_pk_mul_f32 v[76:77], v[76:77], v[36:37]
  v_pk_mul_f32 v[78:79], v[78:79], v[38:39]
  v_cvt_pk_bf16_f32 v40, v72, v73
  v_cvt_pk_bf16_f32 v41, v74, v75
  v_cvt_pk_bf16_f32 v42, v76, v77
  v_cvt_pk_bf16_f32 v43, v78, v79
  buffer_store_dwordx4 v[40:43], v4, s[16:19], 0 offen offset:1024 sc1
  v_pk_mul_f32 v[16:17], v[80:81], v[14:15] op_sel_hi:[1,0]
  v_pk_mul_f32 v[18:19], v[82:83], v[14:15] op_sel_hi:[1,0]
  v_pk_mul_f32 v[20:21], v[84:85], v[14:15] op_sel_hi:[1,0]
  v_pk_mul_f32 v[22:23], v[86:87], v[14:15] op_sel_hi:[1,0]
  v_exp_f32 v16, v16
  v_exp_f32 v17, v17
  v_exp_f32 v18, v18
  v_exp_f32 v19, v19
  v_exp_f32 v20, v20
  v_exp_f32 v21, v21
  v_exp_f32 v22, v22
  v_exp_f32 v23, v23
  v_pk_mul_f32 v[88:89], v[80:81], v[88:89]
  v_pk_mul_f32 v[90:91], v[82:83], v[90:91]
  v_pk_mul_f32 v[92:93], v[84:85], v[92:93]
  v_pk_mul_f32 v[94:95], v[86:87], v[94:95]
  v_pk_fma_f32 v[16:17], v[16:17], v[14:15], v[14:15] op_sel:[0,1,1] op_sel_hi:[1,1,1]
  v_pk_fma_f32 v[18:19], v[18:19], v[14:15], v[14:15] op_sel:[0,1,1] op_sel_hi:[1,1,1]
  v_pk_fma_f32 v[20:21], v[20:21], v[14:15], v[14:15] op_sel:[0,1,1] op_sel_hi:[1,1,1]
  v_pk_fma_f32 v[22:23], v[22:23], v[14:15], v[14:15] op_sel:[0,1,1] op_sel_hi:[1,1,1]
  v_rcp_f32 v16, v16
  v_rcp_f32 v17, v17
  v_rcp_f32 v18, v18
  v_rcp_f32 v19, v19
  v_rcp_f32 v20, v20
  v_rcp_f32 v21, v21
  v_rcp_f32 v22, v22
  v_rcp_f32 v23, v23
  s_nop 0
  v_pk_mul_f32 v[88:89], v[88:89], v[16:17]
  v_pk_mul_f32 v[90:91], v[90:91], v[18:19]
  v_pk_mul_f32 v[92:93], v[92:93], v[20:21]
  v_pk_mul_f32 v[94:95], v[94:95], v[22:23]
  v_cvt_pk_bf16_f32 v24, v88, v89
  v_cvt_pk_bf16_f32 v25, v90, v91
  v_cvt_pk_bf16_f32 v26, v92, v93
  v_cvt_pk_bf16_f32 v27, v94, v95
  buffer_store_dwordx4 v[24:27], v4, s[16:19], 0 offen offset:2048 sc1
  v_pk_mul_f32 v[32:33], v[96:97], v[14:15] op_sel_hi:[1,0]
  v_pk_mul_f32 v[34:35], v[98:99], v[14:15] op_sel_hi:[1,0]
  v_pk_mul_f32 v[36:37], v[100:101], v[14:15] op_sel_hi:[1,0]
  v_pk_mul_f32 v[38:39], v[102:103], v[14:15] op_sel_hi:[1,0]
  v_exp_f32 v32, v32
  v_exp_f32 v33, v33
  v_exp_f32 v34, v34
  v_exp_f32 v35, v35
  v_exp_f32 v36, v36
  v_exp_f32 v37, v37
  v_exp_f32 v38, v38
  v_exp_f32 v39, v39
  v_pk_mul_f32 v[104:105], v[96:97], v[104:105]
  v_pk_mul_f32 v[106:107], v[98:99], v[106:107]
  v_pk_mul_f32 v[108:109], v[100:101], v[108:109]
  v_pk_mul_f32 v[110:111], v[102:103], v[110:111]
  v_pk_fma_f32 v[32:33], v[32:33], v[14:15], v[14:15] op_sel:[0,1,1] op_sel_hi:[1,1,1]
  v_pk_fma_f32 v[34:35], v[34:35], v[14:15], v[14:15] op_sel:[0,1,1] op_sel_hi:[1,1,1]
  v_pk_fma_f32 v[36:37], v[36:37], v[14:15], v[14:15] op_sel:[0,1,1] op_sel_hi:[1,1,1]
  v_pk_fma_f32 v[38:39], v[38:39], v[14:15], v[14:15] op_sel:[0,1,1] op_sel_hi:[1,1,1]
  v_rcp_f32 v32, v32
  v_rcp_f32 v33, v33
  v_rcp_f32 v34, v34
  v_rcp_f32 v35, v35
  v_rcp_f32 v36, v36
  v_rcp_f32 v37, v37
  v_rcp_f32 v38, v38
  v_rcp_f32 v39, v39
  s_nop 0
  v_pk_mul_f32 v[104:105], v[104:105], v[32:33]
  v_pk_mul_f32 v[106:107], v[106:107], v[34:35]
  v_pk_mul_f32 v[108:109], v[108:109], v[36:37]
  v_pk_mul_f32 v[110:111], v[110:111], v[38:39]
  v_cvt_pk_bf16_f32 v40, v104, v105
  v_cvt_pk_bf16_f32 v41, v106, v107
  v_cvt_pk_bf16_f32 v42, v108, v109
  v_cvt_pk_bf16_f32 v43, v110, v111
  buffer_store_dwordx4 v[40:43], v4, s[16:19], 0 offen offset:3072 sc1
  s_waitcnt vmcnt(0)
  s_barrier
  s_cmp_lg_u32 s40, 0
  s_cbranch_scc1 ffn_kernel_arrd
  s_lshl_b32 s47, s45, 8
  v_mov_b32 v5, s47
  v_mov_b32 v6, 1
  s_mov_b64 exec, 1
  buffer_atomic_add v6, v5, s[24:27], 0 offen sc1
  s_mov_b64 exec, -1
ffn_kernel_arrd:
  s_add_u32 m0, s56, 49152
  s_add_u32 s55, s55, 16384
  buffer_load_dwordx4 v124, s[20:23], s55 offen lds
  s_add_u32 m0, s56, 114688
  s_add_u32 s55, s55, 16384
  buffer_load_dwordx4 v124, s[20:23], s55 offen lds
  s_add_u32 m0, s56, 57344
  s_add_u32 s55, s55, 16384
  buffer_load_dwordx4 v124, s[20:23], s55 offen lds
  s_add_u32 m0, s56, 122880
  s_add_u32 s55, s55, 16384
  buffer_load_dwordx4 v124, s[20:23], s55 offen lds
  s_branch ffn_kernel_p2
ffn_kernel_helper:
  s_sub_u32 s57, s2, 224
  s_waitcnt lgkmcnt(0)
  s_add_u32 s12, s34, 0x400000
  s_addc_u32 s13, s35, 0
  s_mov_b32 s14, 0x200000
  s_mov_b32 s15, 0x20000
  s_mov_b32 s20, s32
  s_mov_b32 s21, s33
  s_mov_b32 s22, 0x1c0000
  s_mov_b32 s23, 0x20000
  s_add_u32 s24, s34, 0x1040000
  s_addc_u32 s25, s35, 0
  s_mov_b32 s26, 0x1000
  s_mov_b32 s27, 0x20000
  s_cmp_eq_u32 s41, 0
  s_cselect_b32 s8, s4, s6
  s_cselect_b32 s9, s5, s7
  s_mov_b32 s10, 1835008
  s_mov_b32 s11, 0x20000
  s_add_u32 s28, s34, 0x1050000
  s_addc_u32 s29, s35, 0
  s_mov_b32 s30, 0x4000
  s_mov_b32 s31, 0x20000
  s_lshl_b32 s47, s57, 9
  v_lshlrev_b32 v6, 3, v1
  buffer_load_dword v126, v6, s[28:31], s47 offen offset:4
  s_lshl_b32 s47, s57, 1
  s_add_u32 s47, s47, s41
  s_lshl_b32 s47, s47, 15
  s_lshl_b32 s48, s53, 13
  s_add_u32 s47, s47, s48
  v_lshlrev_b32 v5, 4, v1
  buffer_load_dwordx4 v[16:19], v5, s[12:15], s47 offen offset:0
  buffer_load_dwordx4 v[20:23], v5, s[12:15], s47 offen offset:1024
  buffer_load_dwordx4 v[24:27], v5, s[12:15], s47 offen offset:2048
  buffer_load_dwordx4 v[28:31], v5, s[12:15], s47 offen offset:3072
  s_add_u32 s47, s47, 4096
  buffer_load_dwordx4 v[32:35], v5, s[12:15], s47 offen offset:0
  buffer_load_dwordx4 v[36:39], v5, s[12:15], s47 offen offset:1024
  buffer_load_dwordx4 v[40:43], v5, s[12:15], s47 offen offset:2048
  buffer_load_dwordx4 v[44:47], v5, s[12:15], s47 offen offset:3072
  s_add_u32 s28, s34, 0x1008000
  s_addc_u32 s29, s35, 0
  s_mov_b32 s30, 0x1800
  s_mov_b32 s31, 0x20000
  v_and_b32 v6, 31, v1
  v_lshrrev_b32 v7, 5, v1
  v_lshlrev_b32 v9, 4, v7
  v_lshlrev_b32 v7, 10, v6
  v_sub_u32 v7, 4096, v7
  v_add_u32 v9, v9, v7
  v_cmp_lt_u32 vcc, 1, v6
  v_mov_b32 v7, 0x40000000
  s_lshl_b32 s47, s40, 7
  v_cndmask_b32 v9, v9, v7, vcc
  buffer_load_dwordx4 a[0:3], v9, s[28:31], s47 offen offset:0
  buffer_load_dwordx4 a[4:7], v9, s[28:31], s47 offen offset:32
  buffer_load_dwordx4 a[8:11], v9, s[28:31], s47 offen offset:64
  buffer_load_dwordx4 a[12:15], v9, s[28:31], s47 offen offset:96
  v_lshrrev_b32 v5, 3, v1
  v_bfe_u32 v6, v1, 4, 1
  v_bfe_u32 v7, v1, 1, 2
  v_xor_b32 v6, v6, v7
  v_and_b32 v7, 1, v1
  v_lshlrev_b32 v7, 4, v7
  s_movk_i32 s48, 3584
  v_mad_u32_u24 v5, v5, s48, v7
  v_lshl_add_u32 v10, v6, 5, v5
  v_xor_b32 v6, 2, v6
  v_lshl_add_u32 v11, v6, 5, v5
  s_and_b32 s48, s57, 1
  s_lshl_b32 s48, s48, 2
  s_lshr_b32 s49, s57, 3
  s_add_u32 s60, s48, s49
  s_bfe_u32 s48, s57, 0x20001
  s_mul_i32 s48, s48, 7
  s_min_u32 s49, s60, 6
  s_add_u32 s61, s48, s49
  s_lshl_b32 s49, s61, 7
  s_mul_i32 s48, s40, 229376
  s_add_u32 s49, s49, s48
  s_lshl_b32 s50, s40, 13
  s_mov_b32 s8, s4
  s_mov_b32 s9, s5
  s_mov_b32 s10, 0x1c0000
  s_mov_b32 s11, 0x20000
  s_mov_b32 s16, s6
  s_mov_b32 s17, s7
  s_mov_b32 s18, 0x1c0000
  s_mov_b32 s19, 0x20000
  s_add_u32 m0, s50, 0
  s_nop 0
  buffer_load_dwordx4 v10, s[8:11], s49 offen lds
  s_add_u32 m0, s50, 65536
  s_nop 0
  buffer_load_dwordx4 v11, s[16:19], s49 offen lds
  s_add_u32 s49, s49, 28672
  s_add_u32 m0, s50, 1024
  s_nop 0
  buffer_load_dwordx4 v10, s[8:11], s49 offen lds
  s_add_u32 m0, s50, 66560
  s_nop 0
  buffer_load_dwordx4 v11, s[16:19], s49 offen lds
  s_add_u32 s49, s49, 28672
  s_add_u32 m0, s50, 2048
  s_nop 0
  buffer_load_dwordx4 v10, s[8:11], s49 offen lds
  s_add_u32 m0, s50, 67584
  s_nop 0
  buffer_load_dwordx4 v11, s[16:19], s49 offen lds
  s_add_u32 s49, s49, 28672
  s_add_u32 m0, s50, 3072
  s_nop 0
  buffer_load_dwordx4 v10, s[8:11], s49 offen lds
  s_add_u32 m0, s50, 68608
  s_nop 0
  buffer_load_dwordx4 v11, s[16:19], s49 offen lds
  s_add_u32 s49, s49, 28672
  s_add_u32 m0, s50, 4096
  s_nop 0
  buffer_load_dwordx4 v10, s[8:11], s49 offen lds
  s_add_u32 m0, s50, 69632
  s_nop 0
  buffer_load_dwordx4 v11, s[16:19], s49 offen lds
  s_add_u32 s49, s49, 28672
  s_add_u32 m0, s50, 5120
  s_nop 0
  buffer_load_dwordx4 v10, s[8:11], s49 offen lds
  s_add_u32 m0, s50, 70656
  s_nop 0
  buffer_load_dwordx4 v11, s[16:19], s49 offen lds
  s_add_u32 s49, s49, 28672
  s_add_u32 m0, s50, 6144
  s_nop 0
  buffer_load_dwordx4 v10, s[8:11], s49 offen lds
  s_add_u32 m0, s50, 71680
  s_nop 0
  buffer_load_dwordx4 v11, s[16:19], s49 offen lds
  s_add_u32 s49, s49, 28672
  s_add_u32 m0, s50, 7168
  s_nop 0
  buffer_load_dwordx4 v10, s[8:11], s49 offen lds
  s_add_u32 m0, s50, 72704
  s_nop 0
  buffer_load_dwordx4 v11, s[16:19], s49 offen lds
  v_bfe_u32 v6, v1, 2, 2
  v_lshrrev_b32 v7, 5, v1
  v_lshl_add_u32 v7, v7, 3, v6
  v_bfe_u32 v8, v1, 4, 1
  v_lshlrev_b32 v7, 7, v7
  v_lshl_add_u32 v7, v8, 16, v7
  v_lshrrev_b32 v6, 1, v6
  v_lshl_or_b32 v6, v8, 1, v6
  v_and_b32 v8, 1, v1
  v_lshl_add_u32 v7, v8, 4, v7
  v_bfe_u32 v8, v1, 1, 1
  v_lshl_add_u32 v7, v8, 3, v7
  v_add_u32 v7, s50, v7
  v_xor_b32 v8, 0, v6
  v_lshl_add_u32 v112, v8, 5, v7
  v_xor_b32 v8, 1, v6
  v_lshl_add_u32 v113, v8, 5, v7
  v_xor_b32 v8, 2, v6
  v_lshl_add_u32 v114, v8, 5, v7
  v_xor_b32 v8, 3, v6
  v_lshl_add_u32 v115, v8, 5, v7
  v_mov_b32 v48, 0
  v_mov_b32 v49, 0
  v_mov_b32 v50, 0
  v_mov_b32 v51, 0
  s_waitcnt vmcnt(20)
  v_lshlrev_b32 v52, 16, v16
  v_and_b32 v53, 0xffff0000, v16
  v_pk_add_f32 v[48:49], v[48:49], v[52:53]
  v_pk_fma_f32 v[50:51], v[52:53], v[52:53], v[50:51]
  v_lshlrev_b32 v54, 16, v17
  v_and_b32 v55, 0xffff0000, v17
  v_pk_add_f32 v[48:49], v[48:49], v[54:55]
  v_pk_fma_f32 v[50:51], v[54:55], v[54:55], v[50:51]
  v_lshlrev_b32 v52, 16, v18
  v_and_b32 v53, 0xffff0000, v18
  v_pk_add_f32 v[48:49], v[48:49], v[52:53]
  v_pk_fma_f32 v[50:51], v[52:53], v[52:53], v[50:51]
  v_lshlrev_b32 v54, 16, v19
  v_and_b32 v55, 0xffff0000, v19
  v_pk_add_f32 v[48:49], v[48:49], v[54:55]
  v_pk_fma_f32 v[50:51], v[54:55], v[54:55], v[50:51]
  v_lshlrev_b32 v52, 16, v20
  v_and_b32 v53, 0xffff0000, v20
  v_pk_add_f32 v[48:49], v[48:49], v[52:53]
  v_pk_fma_f32 v[50:51], v[52:53], v[52:53], v[50:51]
  v_lshlrev_b32 v54, 16, v21
  v_and_b32 v55, 0xffff0000, v21
  v_pk_add_f32 v[48:49], v[48:49], v[54:55]
  v_pk_fma_f32 v[50:51], v[54:55], v[54:55], v[50:51]
  v_lshlrev_b32 v52, 16, v22
  v_and_b32 v53, 0xffff0000, v22
  v_pk_add_f32 v[48:49], v[48:49], v[52:53]
  v_pk_fma_f32 v[50:51], v[52:53], v[52:53], v[50:51]
  v_lshlrev_b32 v54, 16, v23
  v_and_b32 v55, 0xffff0000, v23
  v_pk_add_f32 v[48:49], v[48:49], v[54:55]
  v_pk_fma_f32 v[50:51], v[54:55], v[54:55], v[50:51]
  v_lshlrev_b32 v52, 16, v24
  v_and_b32 v53, 0xffff0000, v24
  v_pk_add_f32 v[48:49], v[48:49], v[52:53]
  v_pk_fma_f32 v[50:51], v[52:53], v[52:53], v[50:51]
  v_lshlrev_b32 v54, 16, v25
  v_and_b32 v55, 0xffff0000, v25
  v_pk_add_f32 v[48:49], v[48:49], v[54:55]
  v_pk_fma_f32 v[50:51], v[54:55], v[54:55], v[50:51]
  v_lshlrev_b32 v52, 16, v26
  v_and_b32 v53, 0xffff0000, v26
  v_pk_add_f32 v[48:49], v[48:49], v[52:53]
  v_pk_fma_f32 v[50:51], v[52:53], v[52:53], v[50:51]
  v_lshlrev_b32 v54, 16, v27
  v_and_b32 v55, 0xffff0000, v27
  v_pk_add_f32 v[48:49], v[48:49], v[54:55]
  v_pk_fma_f32 v[50:51], v[54:55], v[54:55], v[50:51]
  v_lshlrev_b32 v52, 16, v28
  v_and_b32 v53, 0xffff0000, v28
  v_pk_add_f32 v[48:49], v[48:49], v[52:53]
  v_pk_fma_f32 v[50:51], v[52:53], v[52:53], v[50:51]
  v_lshlrev_b32 v54, 16, v29
  v_and_b32 v55, 0xffff0000, v29
  v_pk_add_f32 v[48:49], v[48:49], v[54:55]
  v_pk_fma_f32 v[50:51], v[54:55], v[54:55], v[50:51]
  v_lshlrev_b32 v52, 16, v30
  v_and_b32 v53, 0xffff0000, v30
  v_pk_add_f32 v[48:49], v[48:49], v[52:53]
  v_pk_fma_f32 v[50:51], v[52:53], v[52:53], v[50:51]
  v_lshlrev_b32 v54, 16, v31
  v_and_b32 v55, 0xffff0000, v31
  v_pk_add_f32 v[48:49], v[48:49], v[54:55]
  v_pk_fma_f32 v[50:51], v[54:55], v[54:55], v[50:51]
  v_lshlrev_b32 v52, 16, v32
  v_and_b32 v53, 0xffff0000, v32
  v_pk_add_f32 v[48:49], v[48:49], v[52:53]
  v_pk_fma_f32 v[50:51], v[52:53], v[52:53], v[50:51]
  v_lshlrev_b32 v54, 16, v33
  v_and_b32 v55, 0xffff0000, v33
  v_pk_add_f32 v[48:49], v[48:49], v[54:55]
  v_pk_fma_f32 v[50:51], v[54:55], v[54:55], v[50:51]
  v_lshlrev_b32 v52, 16, v34
  v_and_b32 v53, 0xffff0000, v34
  v_pk_add_f32 v[48:49], v[48:49], v[52:53]
  v_pk_fma_f32 v[50:51], v[52:53], v[52:53], v[50:51]
  v_lshlrev_b32 v54, 16, v35
  v_and_b32 v55, 0xffff0000, v35
  v_pk_add_f32 v[48:49], v[48:49], v[54:55]
  v_pk_fma_f32 v[50:51], v[54:55], v[54:55], v[50:51]
  v_lshlrev_b32 v52, 16, v36
  v_and_b32 v53, 0xffff0000, v36
  v_pk_add_f32 v[48:49], v[48:49], v[52:53]
  v_pk_fma_f32 v[50:51], v[52:53], v[52:53], v[50:51]
  v_lshlrev_b32 v54, 16, v37
  v_and_b32 v55, 0xffff0000, v37
  v_pk_add_f32 v[48:49], v[48:49], v[54:55]
  v_pk_fma_f32 v[50:51], v[54:55], v[54:55], v[50:51]
  v_lshlrev_b32 v52, 16, v38
  v_and_b32 v53, 0xffff0000, v38
  v_pk_add_f32 v[48:49], v[48:49], v[52:53]
  v_pk_fma_f32 v[50:51], v[52:53], v[52:53], v[50:51]
  v_lshlrev_b32 v54, 16, v39
  v_and_b32 v55, 0xffff0000, v39
  v_pk_add_f32 v[48:49], v[48:49], v[54:55]
  v_pk_fma_f32 v[50:51], v[54:55], v[54:55], v[50:51]
  v_lshlrev_b32 v52, 16, v40
  v_and_b32 v53, 0xffff0000, v40
  v_pk_add_f32 v[48:49], v[48:49], v[52:53]
  v_pk_fma_f32 v[50:51], v[52:53], v[52:53], v[50:51]
  v_lshlrev_b32 v54, 16, v41
  v_and_b32 v55, 0xffff0000, v41
  v_pk_add_f32 v[48:49], v[48:49], v[54:55]
  v_pk_fma_f32 v[50:51], v[54:55], v[54:55], v[50:51]
  v_lshlrev_b32 v52, 16, v42
  v_and_b32 v53, 0xffff0000, v42
  v_pk_add_f32 v[48:49], v[48:49], v[52:53]
  v_pk_fma_f32 v[50:51], v[52:53], v[52:53], v[50:51]
  v_lshlrev_b32 v54, 16, v43
  v_and_b32 v55, 0xffff0000, v43
  v_pk_add_f32 v[48:49], v[48:49], v[54:55]
  v_pk_fma_f32 v[50:51], v[54:55], v[54:55], v[50:51]
  v_lshlrev_b32 v52, 16, v44
  v_and_b32 v53, 0xffff0000, v44
  v_pk_add_f32 v[48:49], v[48:49], v[52:53]
  v_pk_fma_f32 v[50:51], v[52:53], v[52:53], v[50:51]
  v_lshlrev_b32 v54, 16, v45
  v_and_b32 v55, 0xffff0000, v45
  v_pk_add_f32 v[48:49], v[48:49], v[54:55]
  v_pk_fma_f32 v[50:51], v[54:55], v[54:55], v[50:51]
  v_lshlrev_b32 v52, 16, v46
  v_and_b32 v53, 0xffff0000, v46
  v_pk_add_f32 v[48:49], v[48:49], v[52:53]
  v_pk_fma_f32 v[50:51], v[52:53], v[52:53], v[50:51]
  v_lshlrev_b32 v54, 16, v47
  v_and_b32 v55, 0xffff0000, v47
  v_pk_add_f32 v[48:49], v[48:49], v[54:55]
  v_pk_fma_f32 v[50:51], v[54:55], v[54:55], v[50:51]
  v_add_f32 v12, v48, v49
  v_add_f32 v13, v50, v51
  s_nop 1
  v_permlane32_swap_b32 v12, v13
  s_nop 1
  v_add_f32 v12, v12, v13
  s_lshl_b32 s47, s41, 2
  s_add_u32 s47, s47, s53
  s_lshl_b32 s47, s47, 8
  s_add_u32 s47, s47, 131072
  v_lshlrev_b32 v5, 2, v1
  v_add_u32 v5, s47, v5
  ds_write_b32 v5, v12 offset:0
  s_waitcnt vmcnt(0)
  ds_read_b64_tr_b16 v[16:17], v112 offset:0
  ds_read_b64_tr_b16 v[18:19], v112 offset:512
  ds_read_b64_tr_b16 v[20:21], v113 offset:0
  ds_read_b64_tr_b16 v[22:23], v113 offset:512
  ds_read_b64_tr_b16 v[24:25], v114 offset:0
  ds_read_b64_tr_b16 v[26:27], v114 offset:512
  ds_read_b64_tr_b16 v[28:29], v115 offset:0
  ds_read_b64_tr_b16 v[30:31], v115 offset:512
  ds_read_b64_tr_b16 v[32:33], v112 offset:2048
  ds_read_b64_tr_b16 v[34:35], v112 offset:2560
  ds_read_b64_tr_b16 v[36:37], v113 offset:2048
  ds_read_b64_tr_b16 v[38:39], v113 offset:2560
  ds_read_b64_tr_b16 v[40:41], v114 offset:2048
  ds_read_b64_tr_b16 v[42:43], v114 offset:2560
  ds_read_b64_tr_b16 v[44:45], v115 offset:2048
  ds_read_b64_tr_b16 v[46:47], v115 offset:2560
  s_waitcnt lgkmcnt(8)
  v_mfma_f32_32x32x16_bf16 v[48:63], a[0:3], v[16:19], 0
  v_mfma_f32_32x32x16_bf16 v[64:79], a[0:3], v[20:23], 0
  v_mfma_f32_32x32x16_bf16 v[80:95], a[0:3], v[24:27], 0
  v_mfma_f32_32x32x16_bf16 v[96:111], a[0:3], v[28:31], 0
  ds_read_b64_tr_b16 v[16:17], v112 offset:4096
  ds_read_b64_tr_b16 v[18:19], v112 offset:4608
  ds_read_b64_tr_b16 v[20:21], v113 offset:4096
  ds_read_b64_tr_b16 v[22:23], v113 offset:4608
  ds_read_b64_tr_b16 v[24:25], v114 offset:4096
  ds_read_b64_tr_b16 v[26:27], v114 offset:4608
  ds_read_b64_tr_b16 v[28:29], v115 offset:4096
  ds_read_b64_tr_b16 v[30:31], v115 offset:4608
  s_waitcnt lgkmcnt(8)
  v_mfma_f32_32x32x16_bf16 v[48:63], a[4:7], v[32:35], v[48:63]
  v_mfma_f32_32x32x16_bf16 v[64:79], a[4:7], v[36:39], v[64:79]
  v_mfma_f32_32x32x16_bf16 v[80:95], a[4:7], v[40:43], v[80:95]
  v_mfma_f32_32x32x16_bf16 v[96:111], a[4:7], v[44:47], v[96:111]
  ds_read_b64_tr_b16 v[32:33], v112 offset:6144
  ds_read_b64_tr_b16 v[34:35], v112 offset:6656
  ds_read_b64_tr_b16 v[36:37], v113 offset:6144
  ds_read_b64_tr_b16 v[38:39], v113 offset:6656
  ds_read_b64_tr_b16 v[40:41], v114 offset:6144
  ds_read_b64_tr_b16 v[42:43], v114 offset:6656
  ds_read_b64_tr_b16 v[44:45], v115 offset:6144
  ds_read_b64_tr_b16 v[46:47], v115 offset:6656
  s_waitcnt lgkmcnt(8)
  v_mfma_f32_32x32x16_bf16 v[48:63], a[8:11], v[16:19], v[48:63]
  v_mfma_f32_32x32x16_bf16 v[64:79], a[8:11], v[20:23], v[64:79]
  v_mfma_f32_32x32x16_bf16 v[80:95], a[8:11], v[24:27], v[80:95]
  v_mfma_f32_32x32x16_bf16 v[96:111], a[8:11], v[28:31], v[96:111]
  s_waitcnt lgkmcnt(0)
  v_mfma_f32_32x32x16_bf16 v[48:63], a[12:15], v[32:35], v[48:63]
  v_mfma_f32_32x32x16_bf16 v[64:79], a[12:15], v[36:39], v[64:79]
  v_mfma_f32_32x32x16_bf16 v[80:95], a[12:15], v[40:43], v[80:95]
  v_mfma_f32_32x32x16_bf16 v[96:111], a[12:15], v[44:47], v[96:111]
  s_lshl_b32 s47, s40, 10
  s_add_u32 s47, s47, 133120
  v_lshlrev_b32 v5, 3, v1
  v_add_u32 v5, s47, v5
  s_mov_b32 s58, -1
  s_mov_b32 s59, 0
  s_nop 7
  s_mov_b64 exec, s[58:59]
  ds_write_b64 v5, v[48:49] offset:0
  ds_write_b64 v5, v[64:65] offset:256
  ds_write_b64 v5, v[80:81] offset:512
  ds_write_b64 v5, v[96:97] offset:768
  s_mov_b64 exec, -1
  s_waitcnt lgkmcnt(0)
  s_barrier
  s_cmp_eq_u32 s40, 0
  s_cbranch_scc1 ffn_kernel_hstat
  s_cmp_eq_u32 s53, 1
  s_cbranch_scc0 ffn_kernel_hdone
  s_lshl_b32 s47, s41, 9
  s_add_u32 s47, s47, 133120
  v_lshlrev_b32 v5, 3, v1
  v_add_u32 v5, s47, v5
  ds_read_b64 v[48:49], v5 offset:0
  ds_read_b64 v[50:51], v5 offset:1024
  ds_read_b64 v[52:53], v5 offset:2048
  ds_read_b64 v[54:55], v5 offset:3072
  ds_read_b64 v[56:57], v5 offset:4096
  ds_read_b64 v[58:59], v5 offset:5120
  ds_read_b64 v[60:61], v5 offset:6144
  ds_read_b64 v[62:63], v5 offset:7168
  s_waitcnt lgkmcnt(0)
  v_add_f32 v48, v48, v50
  v_add_f32 v49, v49, v51
  v_add_f32 v48, v48, v52
  v_add_f32 v49, v49, v53
  v_add_f32 v48, v48, v54
  v_add_f32 v49, v49, v55
  v_add_f32 v48, v48, v56
  v_add_f32 v49, v49, v57
  v_add_f32 v48, v48, v58
  v_add_f32 v49, v49, v59
  v_add_f32 v48, v48, v60
  v_add_f32 v49, v49, v61
  v_add_f32 v48, v48, v62
  v_add_f32 v49, v49, v63
  v_mov_b32 v16, v48
  v_mov_b32 v20, v49
  v_cvt_pk_bf16_f32 v24, v16, v16
  v_lshlrev_b32 v26, 16, v24
  v_sub_f32 v26, v16, v26
  v_cvt_pk_bf16_f32 v25, v26, v26
  v_and_b32 v24, 0xffff, v24
  v_and_b32 v25, 0xffff, v25
  v_cvt_pk_bf16_f32 v27, v20, v20
  v_lshlrev_b32 v26, 16, v27
  v_sub_f32 v26, v20, v26
  v_cvt_pk_bf16_f32 v28, v26, v26
  v_and_b32 v27, 0xffff, v27
  v_and_b32 v28, 0xffff, v28
  v_lshl_or_b32 v32, v24, 16, v24
  v_mov_b32 v33, v25
  v_lshl_or_b32 v34, v27, 16, v27
  v_mov_b32 v35, v28
  s_add_u32 s28, s34, 0x1010000
  s_addc_u32 s29, s35, 0
  s_mov_b32 s30, 0xe000
  s_mov_b32 s31, 0x20000
  s_cmp_ge_u32 s60, 7
  s_cbranch_scc1 ffn_kernel_hdone
  v_and_b32 v6, 3, v1
  v_bfe_u32 v7, v1, 2, 1
  v_lshl_add_u32 v6, v7, 3, v6
  v_bfe_u32 v7, v1, 3, 1
  v_lshl_add_u32 v6, v7, 2, v6
  v_lshrrev_b32 v7, 5, v1
  v_lshl_add_u32 v6, v7, 4, v6
  v_bfe_u32 v7, v1, 4, 1
  v_mul_u32_u24 v7, 1792, v7
  v_add_u32 v6, v6, v7
  s_lshl_b32 s47, s41, 5
  s_lshl_b32 s48, s61, 6
  s_add_u32 s47, s47, s48
  s_lshl_b32 s47, s47, 4
  v_lshlrev_b32 v5, 4, v6
  buffer_store_dwordx4 v[32:35], v5, s[28:31], s47 offen sc1
  s_branch ffn_kernel_hdone
ffn_kernel_hstat:
  v_lshrrev_b32 v5, 5, v1
  v_lshlrev_b32 v5, 10, v5
  v_and_b32 v6, 31, v1
  v_lshl_add_u32 v5, v6, 2, v5
  v_add_u32 v5, 131072, v5
  ds_read_b32 v16, v5 offset:0
  ds_read_b32 v20, v5 offset:128
  ds_read_b32 v17, v5 offset:256
  ds_read_b32 v21, v5 offset:384
  ds_read_b32 v18, v5 offset:512
  ds_read_b32 v22, v5 offset:640
  ds_read_b32 v19, v5 offset:768
  ds_read_b32 v23, v5 offset:896
  s_waitcnt lgkmcnt(0)
  v_add_f32 v16, v16, v17
  v_add_f32 v18, v18, v19
  v_add_f32 v16, v16, v18
  v_add_f32 v20, v20, v21
  v_add_f32 v22, v22, v23
  v_add_f32 v20, v20, v22
  s_mov_b32 s47, 0x3b000000
  s_mov_b32 s48, 0x3727c5ac
  v_mul_f32 v16, s47, v16
  v_mul_f32 v20, s47, v20
  v_fma_f32 v20, -v16, v16, v20
  v_max_f32 v20, 0, v20
  v_add_f32 v20, s48, v20
  v_sqrt_f32 v21, v20
  v_rsq_f32 v22, v20
  v_sub_f32 v16, v126, v16
  s_mov_b32 s47, 0xbfb8aa3b
  v_mul_f32 v18, s47, v22
  v_mov_b32 v19, v20
  v_cvt_pk_bf16_f32 v24, v16, v16
  v_lshlrev_b32 v26, 16, v24
  v_sub_f32 v26, v16, v26
  v_cvt_pk_bf16_f32 v25, v26, v26
  v_and_b32 v24, 0xffff, v24
  v_and_b32 v25, 0xffff, v25
  v_cvt_pk_bf16_f32 v27, v21, v21
  v_lshlrev_b32 v26, 16, v27
  v_sub_f32 v26, v21, v26
  v_cvt_pk_bf16_f32 v28, v26, v26
  v_and_b32 v27, 0xffff, v27
  v_and_b32 v28, 0xffff, v28
  v_lshl_or_b32 v32, v25, 16, v24
  v_mov_b32 v33, v24
  v_lshl_or_b32 v34, v28, 16, v27
  v_mov_b32 v35, v27
  s_add_u32 s28, s34, 0x1020000
  s_addc_u32 s29, s35, 0
  s_mov_b32 s30, 0x8000
  s_mov_b32 s31, 0x20000
  s_add_u32 s12, s34, 0x1030000
  s_addc_u32 s13, s35, 0
  s_mov_b32 s14, 0x4000
  s_mov_b32 s15, 0x20000
  s_lshl_b32 s47, s57, 10
  v_lshlrev_b32 v5, 4, v1
  buffer_store_dwordx4 v[32:35], v5, s[28:31], s47 offen sc1
  s_lshl_b32 s47, s57, 9
  v_lshlrev_b32 v5, 3, v1
  buffer_store_dwordx2 v[18:19], v5, s[12:15], s47 offen sc1
ffn_kernel_hdone:
  s_waitcnt vmcnt(0)
  s_barrier
  s_cmp_lg_u32 s40, 0
  s_cbranch_scc1 ffn_kernel_hsig
  v_lshlrev_b32 v5, 8, v1
  v_add_u32 v5, 2048, v5
  v_mov_b32 v6, 1
  s_mov_b64 exec, 0xff
  buffer_atomic_add v6, v5, s[24:27], 0 offen sc1
  s_mov_b64 exec, -1
ffn_kernel_hsig:
  v_lshrrev_b32 v5, 3, v1
  v_lshrrev_b32 v6, 1, v5
  v_lshrrev_b32 v7, 2, v1
  v_xor_b32 v6, v6, v7
  v_and_b32 v6, 1, v6
  v_lshlrev_b32 v6, 6, v6
  v_and_b32 v7, 3, v1
  v_lshl_add_u32 v6, v7, 4, v6
  v_lshl_add_u32 v124, v5, 10, v6
  s_mul_i32 s55, s53, 458752
  s_lshl_b32 s47, s54, 13
  s_add_u32 s55, s55, s47
  s_lshl_b32 s47, s51, 7
  s_add_u32 s55, s55, s47
  s_lshl_b32 s56, s53, 11
  s_lshl_b32 s47, s54, 10
  s_add_u32 s56, s56, s47
  s_add_u32 m0, s56, 131072
  s_nop 0
  buffer_load_dwordx4 v124, s[20:23], s55 offen lds
  s_add_u32 m0, s56, 139264
  s_add_u32 s55, s55, 16384
  buffer_load_dwordx4 v124, s[20:23], s55 offen lds
  s_add_u32 m0, s56, 147456
  s_add_u32 s55, s55, 16384
  buffer_load_dwordx4 v124, s[20:23], s55 offen lds
  s_add_u32 m0, s56, 155648
  s_add_u32 s55, s55, 16384
  buffer_load_dwordx4 v124, s[20:23], s55 offen lds
  s_add_u32 m0, s56, 0
  s_add_u32 s55, s55, 16384
  buffer_load_dwordx4 v124, s[20:23], s55 offen lds
  s_add_u32 m0, s56, 65536
  s_add_u32 s55, s55, 16384
  buffer_load_dwordx4 v124, s[20:23], s55 offen lds
  s_add_u32 m0, s56, 8192
  s_add_u32 s55, s55, 16384
  buffer_load_dwordx4 v124, s[20:23], s55 offen lds
  s_add_u32 m0, s56, 73728
  s_add_u32 s55, s55, 16384
  buffer_load_dwordx4 v124, s[20:23], s55 offen lds
  s_add_u32 m0, s56, 16384
  s_add_u32 s55, s55, 16384
  buffer_load_dwordx4 v124, s[20:23], s55 offen lds
  s_add_u32 m0, s56, 81920
  s_add_u32 s55, s55, 16384
  buffer_load_dwordx4 v124, s[20:23], s55 offen lds
  s_add_u32 m0, s56, 24576
  s_add_u32 s55, s55, 16384
  buffer_load_dwordx4 v124, s[20:23], s55 offen lds
  s_add_u32 m0, s56, 90112
  s_add_u32 s55, s55, 16384
  buffer_load_dwordx4 v124, s[20:23], s55 offen lds
  s_add_u32 m0, s56, 32768
  s_add_u32 s55, s55, 16384
  buffer_load_dwordx4 v124, s[20:23], s55 offen lds
  s_add_u32 m0, s56, 98304
  s_add_u32 s55, s55, 16384
  buffer_load_dwordx4 v124, s[20:23], s55 offen lds
  s_add_u32 m0, s56, 40960
  s_add_u32 s55, s55, 16384
  buffer_load_dwordx4 v124, s[20:23], s55 offen lds
  s_add_u32 m0, s56, 106496
  s_add_u32 s55, s55, 16384
  buffer_load_dwordx4 v124, s[20:23], s55 offen lds
  s_add_u32 m0, s56, 49152
  s_add_u32 s55, s55, 16384
  buffer_load_dwordx4 v124, s[20:23], s55 offen lds
  s_add_u32 m0, s56, 114688
  s_add_u32 s55, s55, 16384
  buffer_load_dwordx4 v124, s[20:23], s55 offen lds
  s_add_u32 m0, s56, 57344
  s_add_u32 s55, s55, 16384
  buffer_load_dwordx4 v124, s[20:23], s55 offen lds
  s_add_u32 m0, s56, 122880
  s_add_u32 s55, s55, 16384
  buffer_load_dwordx4 v124, s[20:23], s55 offen lds
  s_waitcnt vmcnt(0)
  s_barrier
ffn_kernel_p2:
  v_lshrrev_b32 v6, 5, v1
  v_lshlrev_b32 v6, 3, v6
  v_bfe_u32 v7, v1, 2, 2
  v_add_u32 v6, v6, v7
  v_lshlrev_b32 v10, 7, v6
  v_lshrrev_b32 v7, 1, v7
  v_lshlrev_b32 v7, 6, v7
  v_and_b32 v6, 1, v1
  v_lshlrev_b32 v6, 5, v6
  v_bfe_u32 v8, v1, 1, 1
  v_lshl_add_u32 v6, v8, 3, v6
  v_bfe_u32 v8, v1, 4, 1
  v_lshl_add_u32 v6, v8, 4, v6
  v_add_u32 v10, v10, v6
  s_lshl_b32 s47, s53, 11
  v_add_u32 v10, s47, v10
  v_xor_b32 v8, 64, v7
  v_add_u32 v11, v10, v8
  v_add_u32 v10, v10, v7
  v_add_u32 v12, 65536, v10
  v_add_u32 v13, 65536, v11
  v_add_u32 v14, 131072, v10
  v_add_u32 v15, 131072, v11
  ds_read_b64_tr_b16 v[32:33], v14 offset:0
  ds_read_b64_tr_b16 v[34:35], v14 offset:512
  ds_read_b64_tr_b16 v[36:37], v15 offset:0
  ds_read_b64_tr_b16 v[38:39], v15 offset:512
  ds_read_b64_tr_b16 v[40:41], v14 offset:8192
  ds_read_b64_tr_b16 v[42:43], v14 offset:8704
  ds_read_b64_tr_b16 v[44:45], v15 offset:8192
  ds_read_b64_tr_b16 v[46:47], v15 offset:8704
  ds_read_b64_tr_b16 v[80:81], v14 offset:16384
  ds_read_b64_tr_b16 v[82:83], v14 offset:16896
  ds_read_b64_tr_b16 v[84:85], v15 offset:16384
  ds_read_b64_tr_b16 v[86:87], v15 offset:16896
  s_waitcnt lgkmcnt(4)
  ds_read_b64_tr_b16 v[88:89], v14 offset:24576
  ds_read_b64_tr_b16 v[90:91], v14 offset:25088
  ds_read_b64_tr_b16 v[92:93], v15 offset:24576
  ds_read_b64_tr_b16 v[94:95], v15 offset:25088
  ds_read_b64_tr_b16 v[96:97], v10 offset:0
  ds_read_b64_tr_b16 v[98:99], v10 offset:512
  ds_read_b64_tr_b16 v[100:101], v11 offset:0
  ds_read_b64_tr_b16 v[102:103], v11 offset:512
  ds_read_b64_tr_b16 v[104:105], v12 offset:0
  ds_read_b64_tr_b16 v[106:107], v12 offset:512
  ds_read_b64_tr_b16 v[108:109], v13 offset:0
  ds_read_b64_tr_b16 v[110:111], v13 offset:512
  s_waitcnt lgkmcnt(4)
  ds_read_b64_tr_b16 a[112:113], v10 offset:8192
  ds_read_b64_tr_b16 a[114:115], v10 offset:8704
  ds_read_b64_tr_b16 a[116:117], v11 offset:8192
  ds_read_b64_tr_b16 a[118:119], v11 offset:8704
  ds_read_b64_tr_b16 a[120:121], v12 offset:8192
  ds_read_b64_tr_b16 a[122:123], v12 offset:8704
  ds_read_b64_tr_b16 a[124:125], v13 offset:8192
  ds_read_b64_tr_b16 a[126:127], v13 offset:8704
  s_waitcnt lgkmcnt(0)
  s_barrier
  s_add_u32 m0, s56, 131072
  s_add_u32 s55, s55, 16384
  buffer_load_dwordx4 v124, s[20:23], s55 offen lds
  s_add_u32 m0, s56, 139264
  s_add_u32 s55, s55, 16384
  buffer_load_dwordx4 v124, s[20:23], s55 offen lds
  s_add_u32 m0, s56, 147456
  s_add_u32 s55, s55, 16384
  buffer_load_dwordx4 v124, s[20:23], s55 offen lds
  s_add_u32 m0, s56, 155648
  s_add_u32 s55, s55, 16384
  buffer_load_dwordx4 v124, s[20:23], s55 offen lds
  s_add_u32 m0, s56, 0
  s_add_u32 s55, s55, 16384
  buffer_load_dwordx4 v124, s[20:23], s55 offen lds
  s_add_u32 m0, s56, 65536
  s_add_u32 s55, s55, 16384
  buffer_load_dwordx4 v124, s[20:23], s55 offen lds
  s_add_u32 m0, s56, 8192
  s_add_u32 s55, s55, 16384
  buffer_load_dwordx4 v124, s[20:23], s55 offen lds
  s_add_u32 m0, s56, 73728
  s_add_u32 s55, s55, 16384
  buffer_load_dwordx4 v124, s[20:23], s55 offen lds
  s_lshl_b32 s47, s52, 1
  s_add_u32 s49, s47, s54
  s_mul_i32 s47, s49, 112
  s_mul_i32 s48, s53, 28
  s_add_u32 s47, s47, s48
  s_lshl_b32 s47, s47, 10
  v_lshlrev_b32 v6, 4, v1
  v_add_u32 v3, s47, v6
  s_lshl_b32 s47, s54, 16
  s_add_u32 s47, s47, 16384
  s_lshl_b32 s48, s53, 11
  s_add_u32 s48, s48, s47
  v_add_u32 v5, s48, v6
  s_lshl_b32 s48, s53, 13
  s_add_u32 s48, s48, s47
  v_add_u32 v9, s48, v6
  s_lshr_b32 s47, s53, 1
  s_lshl_b32 s47, s47, 5
  s_and_b32 s48, s53, 1
  s_lshl_b32 s48, s48, 3
  s_add_u32 s47, s47, s48
  s_lshl_b32 s48, s51, 6
  s_add_u32 s47, s47, s48
  v_lshrrev_b32 v7, 5, v1
  v_lshlrev_b32 v7, 4, v7
  v_add_u32 v7, s47, v7
  v_and_b32 v6, 31, v1
  s_lshl_b32 s48, s49, 15
  v_lshrrev_b32 v8, 4, v7
  v_lshlrev_b32 v8, 10, v8
  v_lshl_add_u32 v8, v6, 4, v8
  v_bfe_u32 v4, v7, 3, 1
  v_lshl_add_u32 v8, v4, 9, v8
  s_add_u32 s12, s34, 0x400000
  s_addc_u32 s13, s35, 0
  s_mov_b32 s14, 0x200000
  s_mov_b32 s15, 0x20000
  buffer_load_dwordx4 v[112:115], v8, s[12:15], s48 offen
  s_add_u32 s28, s34, 0x1002800
  s_addc_u32 s29, s35, 0
  s_mov_b32 s30, 0x800
  s_mov_b32 s31, 0x20000
  v_lshlrev_b32 v8, 2, v7
  buffer_load_dwordx4 v[116:119], v8, s[28:31], 0 offen
  buffer_load_dwordx4 v[120:123], v8, s[28:31], 0 offen offset:16
  s_lshl_b32 s48, s49, 15
  v_lshlrev_b32 v4, 10, v6
  v_lshl_add_u32 v4, v7, 1, v4
  v_add_u32 v4, s48, v4
  s_add_u32 s16, s34, 0x800000
  s_addc_u32 s17, s35, 0
  s_mov_b32 s18, 0x700000
  s_mov_b32 s19, 0x20000
  s_mov_b32 s8, s36
  s_mov_b32 s9, s37
  s_mov_b32 s10, 0x200000
  s_mov_b32 s11, 0x20000
  s_waitcnt vmcnt(0)
  s_cmp_lg_u32 s40, 0
  s_cbranch_scc1 ffn_kernel_s3w
  s_lshr_b32 s47, s52, 2
  s_lshl_b32 s47, s47, 8
  v_mov_b32 v6, s47
  s_mov_b32 s48, 200000
ffn_kernel_s3_lp:
  buffer_load_dword v125, v6, s[24:27], 0 offen sc1
  s_waitcnt vmcnt(0)
  v_readfirstlane_b32 s47, v125
  s_nop 0
  s_cmp_ge_u32 s47, 28
  s_cbranch_scc1 ffn_kernel_s3_ok
  s_sleep 1
  s_sub_u32 s48, s48, 1
  s_cmp_lg_u32 s48, 0
  s_cbranch_scc1 ffn_kernel_s3_lp
ffn_kernel_s3_ok:
ffn_kernel_s3w:
  s_barrier
  s_mov_b32 s47, 0
  buffer_load_dwordx4 a[0:3], v3, s[16:19], s47 offen offset:0 sc1
  buffer_load_dwordx4 a[4:7], v3, s[16:19], s47 offen offset:1024 sc1
  buffer_load_dwordx4 a[8:11], v3, s[16:19], s47 offen offset:2048 sc1
  buffer_load_dwordx4 a[12:15], v3, s[16:19], s47 offen offset:3072 sc1
  s_add_u32 s47, s47, 4096
  buffer_load_dwordx4 a[16:19], v3, s[16:19], s47 offen offset:0 sc1
  s_waitcnt vmcnt(4)
  v_mfma_f32_32x32x16_bf16 v[48:63], v[32:35], a[0:3], 0
  buffer_load_dwordx4 a[20:23], v3, s[16:19], s47 offen offset:1024 sc1
  v_mfma_f32_32x32x16_bf16 v[64:79], v[36:39], a[0:3], 0
  s_waitcnt vmcnt(4)
  v_mfma_f32_32x32x16_bf16 v[48:63], v[40:43], a[4:7], v[48:63]
  buffer_load_dwordx4 a[24:27], v3, s[16:19], s47 offen offset:2048 sc1
  v_mfma_f32_32x32x16_bf16 v[64:79], v[44:47], a[4:7], v[64:79]
  s_waitcnt vmcnt(4)
  v_mfma_f32_32x32x16_bf16 v[48:63], v[80:83], a[8:11], v[48:63]
  buffer_load_dwordx4 a[28:31], v3, s[16:19], s47 offen offset:3072 sc1
  s_add_u32 s47, s47, 4096
  v_mfma_f32_32x32x16_bf16 v[64:79], v[84:87], a[8:11], v[64:79]
  s_waitcnt vmcnt(4)
  v_mfma_f32_32x32x16_bf16 v[48:63], v[88:91], a[12:15], v[48:63]
  buffer_load_dwordx4 a[32:35], v3, s[16:19], s47 offen offset:0 sc1
  v_mfma_f32_32x32x16_bf16 v[64:79], v[92:95], a[12:15], v[64:79]
  s_waitcnt vmcnt(4)
  v_mfma_f32_32x32x16_bf16 v[48:63], v[96:99], a[16:19], v[48:63]
  buffer_load_dwordx4 a[36:39], v3, s[16:19], s47 offen offset:1024 sc1
  v_mfma_f32_32x32x16_bf16 v[64:79], v[100:103], a[16:19], v[64:79]
  s_waitcnt vmcnt(4)
  v_mfma_f32_32x32x16_bf16 v[48:63], v[104:107], a[20:23], v[48:63]
  buffer_load_dwordx4 a[40:43], v3, s[16:19], s47 offen offset:2048 sc1
  v_mfma_f32_32x32x16_bf16 v[64:79], v[108:111], a[20:23], v[64:79]
  s_waitcnt vmcnt(4)
  v_mfma_f32_32x32x16_bf16 v[48:63], a[112:115], a[24:27], v[48:63]
  buffer_load_dwordx4 a[44:47], v3, s[16:19], s47 offen offset:3072 sc1
  s_add_u32 s47, s47, 4096
  v_mfma_f32_32x32x16_bf16 v[64:79], a[116:119], a[24:27], v[64:79]
  ds_read_b64_tr_b16 v[16:17], v10 offset:16384
  ds_read_b64_tr_b16 v[18:19], v10 offset:16896
  ds_read_b64_tr_b16 v[20:21], v11 offset:16384
  ds_read_b64_tr_b16 v[22:23], v11 offset:16896
  s_waitcnt vmcnt(4)
  v_mfma_f32_32x32x16_bf16 v[48:63], a[120:123], a[28:31], v[48:63]
  buffer_load_dwordx4 a[48:51], v3, s[16:19], s47 offen offset:0 sc1
  v_mfma_f32_32x32x16_bf16 v[64:79], a[124:127], a[28:31], v[64:79]
  ds_read_b64_tr_b16 v[24:25], v12 offset:16384
  ds_read_b64_tr_b16 v[26:27], v12 offset:16896
  ds_read_b64_tr_b16 v[28:29], v13 offset:16384
  ds_read_b64_tr_b16 v[30:31], v13 offset:16896
  s_waitcnt vmcnt(4)
  s_waitcnt lgkmcnt(4)
  v_mfma_f32_32x32x16_bf16 v[48:63], v[16:19], a[32:35], v[48:63]
  buffer_load_dwordx4 a[52:55], v3, s[16:19], s47 offen offset:1024 sc1
  v_mfma_f32_32x32x16_bf16 v[64:79], v[20:23], a[32:35], v[64:79]
  ds_read_b64_tr_b16 v[16:17], v10 offset:24576
  ds_read_b64_tr_b16 v[18:19], v10 offset:25088
  ds_read_b64_tr_b16 v[20:21], v11 offset:24576
  ds_read_b64_tr_b16 v[22:23], v11 offset:25088
  s_waitcnt vmcnt(4)
  s_waitcnt lgkmcnt(4)
  v_mfma_f32_32x32x16_bf16 v[48:63], v[24:27], a[36:39], v[48:63]
  buffer_load_dwordx4 a[56:59], v3, s[16:19], s47 offen offset:2048 sc1
  v_mfma_f32_32x32x16_bf16 v[64:79], v[28:31], a[36:39], v[64:79]
  ds_read_b64_tr_b16 v[24:25], v12 offset:24576
  ds_read_b64_tr_b16 v[26:27], v12 offset:25088
  ds_read_b64_tr_b16 v[28:29], v13 offset:24576
  ds_read_b64_tr_b16 v[30:31], v13 offset:25088
  s_waitcnt vmcnt(4)
  s_waitcnt lgkmcnt(4)
  v_mfma_f32_32x32x16_bf16 v[48:63], v[16:19], a[40:43], v[48:63]
  buffer_load_dwordx4 a[60:63], v3, s[16:19], s47 offen offset:3072 sc1
  s_add_u32 s47, s47, 4096
  v_mfma_f32_32x32x16_bf16 v[64:79], v[20:23], a[40:43], v[64:79]
  ds_read_b64_tr_b16 v[16:17], v10 offset:32768
  ds_read_b64_tr_b16 v[18:19], v10 offset:33280
  ds_read_b64_tr_b16 v[20:21], v11 offset:32768
  ds_read_b64_tr_b16 v[22:23], v11 offset:33280
  s_waitcnt vmcnt(4)
  s_waitcnt lgkmcnt(4)
  v_mfma_f32_32x32x16_bf16 v[48:63], v[24:27], a[44:47], v[48:63]
  buffer_load_dwordx4 a[64:67], v3, s[16:19], s47 offen offset:0 sc1
  v_mfma_f32_32x32x16_bf16 v[64:79], v[28:31], a[44:47], v[64:79]
  ds_read_b64_tr_b16 v[24:25], v12 offset:32768
  ds_read_b64_tr_b16 v[26:27], v12 offset:33280
  ds_read_b64_tr_b16 v[28:29], v13 offset:32768
  ds_read_b64_tr_b16 v[30:31], v13 offset:33280
  s_waitcnt vmcnt(4)
  s_waitcnt lgkmcnt(4)
  v_mfma_f32_32x32x16_bf16 v[48:63], v[16:19], a[48:51], v[48:63]
  buffer_load_dwordx4 a[68:71], v3, s[16:19], s47 offen offset:1024 sc1
  v_mfma_f32_32x32x16_bf16 v[64:79], v[20:23], a[48:51], v[64:79]
  ds_read_b64_tr_b16 v[16:17], v10 offset:40960
  ds_read_b64_tr_b16 v[18:19], v10 offset:41472
  ds_read_b64_tr_b16 v[20:21], v11 offset:40960
  ds_read_b64_tr_b16 v[22:23], v11 offset:41472
  s_waitcnt vmcnt(4)
  s_waitcnt lgkmcnt(4)
  v_mfma_f32_32x32x16_bf16 v[48:63], v[24:27], a[52:55], v[48:63]
  buffer_load_dwordx4 a[72:75], v3, s[16:19], s47 offen offset:2048 sc1
  v_mfma_f32_32x32x16_bf16 v[64:79], v[28:31], a[52:55], v[64:79]
  ds_read_b64_tr_b16 v[24:25], v12 offset:40960
  ds_read_b64_tr_b16 v[26:27], v12 offset:41472
  ds_read_b64_tr_b16 v[28:29], v13 offset:40960
  ds_read_b64_tr_b16 v[30:31], v13 offset:41472
  s_waitcnt vmcnt(4)
  s_waitcnt lgkmcnt(4)
  v_mfma_f32_32x32x16_bf16 v[48:63], v[16:19], a[56:59], v[48:63]
  buffer_load_dwordx4 a[76:79], v3, s[16:19], s47 offen offset:3072 sc1
  s_add_u32 s47, s47, 4096
  v_mfma_f32_32x32x16_bf16 v[64:79], v[20:23], a[56:59], v[64:79]
  ds_read_b64_tr_b16 v[16:17], v10 offset:49152
  ds_read_b64_tr_b16 v[18:19], v10 offset:49664
  ds_read_b64_tr_b16 v[20:21], v11 offset:49152
  ds_read_b64_tr_b16 v[22:23], v11 offset:49664
  s_waitcnt vmcnt(4)
  s_waitcnt lgkmcnt(4)
  v_mfma_f32_32x32x16_bf16 v[48:63], v[24:27], a[60:63], v[48:63]
  buffer_load_dwordx4 a[80:83], v3, s[16:19], s47 offen offset:0 sc1
  v_mfma_f32_32x32x16_bf16 v[64:79], v[28:31], a[60:63], v[64:79]
  ds_read_b64_tr_b16 v[24:25], v12 offset:49152
  ds_read_b64_tr_b16 v[26:27], v12 offset:49664
  ds_read_b64_tr_b16 v[28:29], v13 offset:49152
  ds_read_b64_tr_b16 v[30:31], v13 offset:49664
  s_waitcnt vmcnt(4)
  s_waitcnt lgkmcnt(4)
  v_mfma_f32_32x32x16_bf16 v[48:63], v[16:19], a[64:67], v[48:63]
  buffer_load_dwordx4 a[84:87], v3, s[16:19], s47 offen offset:1024 sc1
  v_mfma_f32_32x32x16_bf16 v[64:79], v[20:23], a[64:67], v[64:79]
  ds_read_b64_tr_b16 v[16:17], v10 offset:57344
  ds_read_b64_tr_b16 v[18:19], v10 offset:57856
  ds_read_b64_tr_b16 v[20:21], v11 offset:57344
  ds_read_b64_tr_b16 v[22:23], v11 offset:57856
  s_waitcnt vmcnt(4)
  s_waitcnt lgkmcnt(4)
  v_mfma_f32_32x32x16_bf16 v[48:63], v[24:27], a[68:71], v[48:63]
  buffer_load_dwordx4 a[88:91], v3, s[16:19], s47 offen offset:2048 sc1
  v_mfma_f32_32x32x16_bf16 v[64:79], v[28:31], a[68:71], v[64:79]
  ds_read_b64_tr_b16 v[24:25], v12 offset:57344
  ds_read_b64_tr_b16 v[26:27], v12 offset:57856
  ds_read_b64_tr_b16 v[28:29], v13 offset:57344
  ds_read_b64_tr_b16 v[30:31], v13 offset:57856
  s_waitcnt vmcnt(4)
  s_waitcnt lgkmcnt(4)
  v_mfma_f32_32x32x16_bf16 v[48:63], v[16:19], a[72:75], v[48:63]
  buffer_load_dwordx4 a[92:95], v3, s[16:19], s47 offen offset:3072 sc1
  s_add_u32 s47, s47, 4096
  v_mfma_f32_32x32x16_bf16 v[64:79], v[20:23], a[72:75], v[64:79]
  ds_read_b64_tr_b16 v[16:17], v14 offset:0
  ds_read_b64_tr_b16 v[18:19], v14 offset:512
  ds_read_b64_tr_b16 v[20:21], v15 offset:0
  ds_read_b64_tr_b16 v[22:23], v15 offset:512
  s_waitcnt vmcnt(4)
  s_waitcnt lgkmcnt(4)
  v_mfma_f32_32x32x16_bf16 v[48:63], v[24:27], a[76:79], v[48:63]
  buffer_load_dwordx4 a[96:99], v3, s[16:19], s47 offen offset:0 sc1
  v_mfma_f32_32x32x16_bf16 v[64:79], v[28:31], a[76:79], v[64:79]
  ds_read_b64_tr_b16 v[24:25], v14 offset:8192
  ds_read_b64_tr_b16 v[26:27], v14 offset:8704
  ds_read_b64_tr_b16 v[28:29], v15 offset:8192
  ds_read_b64_tr_b16 v[30:31], v15 offset:8704
  s_waitcnt vmcnt(4)
  s_waitcnt lgkmcnt(4)
  v_mfma_f32_32x32x16_bf16 v[48:63], v[16:19], a[80:83], v[48:63]
  buffer_load_dwordx4 a[100:103], v3, s[16:19], s47 offen offset:1024 sc1
  v_mfma_f32_32x32x16_bf16 v[64:79], v[20:23], a[80:83], v[64:79]
  ds_read_b64_tr_b16 v[16:17], v14 offset:16384
  ds_read_b64_tr_b16 v[18:19], v14 offset:16896
  ds_read_b64_tr_b16 v[20:21], v15 offset:16384
  ds_read_b64_tr_b16 v[22:23], v15 offset:16896
  s_waitcnt vmcnt(4)
  s_waitcnt lgkmcnt(4)
  v_mfma_f32_32x32x16_bf16 v[48:63], v[24:27], a[84:87], v[48:63]
  buffer_load_dwordx4 a[104:107], v3, s[16:19], s47 offen offset:2048 sc1
  v_mfma_f32_32x32x16_bf16 v[64:79], v[28:31], a[84:87], v[64:79]
  s_barrier
  ds_read_b64_tr_b16 v[24:25], v14 offset:24576
  ds_read_b64_tr_b16 v[26:27], v14 offset:25088
  ds_read_b64_tr_b16 v[28:29], v15 offset:24576
  ds_read_b64_tr_b16 v[30:31], v15 offset:25088
  s_waitcnt vmcnt(4)
  s_waitcnt lgkmcnt(4)
  v_mfma_f32_32x32x16_bf16 v[48:63], v[16:19], a[88:91], v[48:63]
  buffer_load_dwordx4 a[108:111], v3, s[16:19], s47 offen offset:3072 sc1
  s_add_u32 s47, s47, 4096
  v_mfma_f32_32x32x16_bf16 v[64:79], v[20:23], a[88:91], v[64:79]
  ds_read_b64_tr_b16 v[16:17], v10 offset:0
  ds_read_b64_tr_b16 v[18:19], v10 offset:512
  ds_read_b64_tr_b16 v[20:21], v11 offset:0
  ds_read_b64_tr_b16 v[22:23], v11 offset:512
  s_waitcnt vmcnt(4)
  s_waitcnt lgkmcnt(4)
  v_mfma_f32_32x32x16_bf16 v[48:63], v[24:27], a[92:95], v[48:63]
  v_mfma_f32_32x32x16_bf16 v[64:79], v[28:31], a[92:95], v[64:79]
  ds_read_b64_tr_b16 v[24:25], v12 offset:0
  ds_read_b64_tr_b16 v[26:27], v12 offset:512
  ds_read_b64_tr_b16 v[28:29], v13 offset:0
  ds_read_b64_tr_b16 v[30:31], v13 offset:512
  s_waitcnt vmcnt(3)
  s_waitcnt lgkmcnt(4)
  v_mfma_f32_32x32x16_bf16 v[48:63], v[16:19], a[96:99], v[48:63]
  v_mfma_f32_32x32x16_bf16 v[64:79], v[20:23], a[96:99], v[64:79]
  ds_read_b64_tr_b16 v[16:17], v10 offset:8192
  ds_read_b64_tr_b16 v[18:19], v10 offset:8704
  ds_read_b64_tr_b16 v[20:21], v11 offset:8192
  ds_read_b64_tr_b16 v[22:23], v11 offset:8704
  s_waitcnt vmcnt(2)
  s_waitcnt lgkmcnt(4)
  v_mfma_f32_32x32x16_bf16 v[48:63], v[24:27], a[100:103], v[48:63]
  v_mfma_f32_32x32x16_bf16 v[64:79], v[28:31], a[100:103], v[64:79]
  ds_read_b64_tr_b16 v[24:25], v12 offset:8192
  ds_read_b64_tr_b16 v[26:27], v12 offset:8704
  ds_read_b64_tr_b16 v[28:29], v13 offset:8192
  ds_read_b64_tr_b16 v[30:31], v13 offset:8704
  s_waitcnt vmcnt(1)
  s_waitcnt lgkmcnt(4)
  v_mfma_f32_32x32x16_bf16 v[48:63], v[16:19], a[104:107], v[48:63]
  v_mfma_f32_32x32x16_bf16 v[64:79], v[20:23], a[104:107], v[64:79]
  s_waitcnt vmcnt(0)
  s_waitcnt lgkmcnt(0)
  v_mfma_f32_32x32x16_bf16 v[48:63], v[24:27], a[108:111], v[48:63]
  v_mfma_f32_32x32x16_bf16 v[64:79], v[28:31], a[108:111], v[64:79]
  v_lshlrev_b32 v80, 16, v112
  v_and_b32 v81, 0xffff0000, v112
  v_lshlrev_b32 v82, 16, v113
  v_and_b32 v83, 0xffff0000, v113
  v_lshlrev_b32 v84, 16, v114
  v_and_b32 v85, 0xffff0000, v114
  v_lshlrev_b32 v86, 16, v115
  v_and_b32 v87, 0xffff0000, v115
  s_nop 4
  ds_write_b128 v5, v[48:51] offset:0
  ds_write_b128 v5, v[52:55] offset:1024
  ds_write_b128 v5, v[56:59] offset:8192
  ds_write_b128 v5, v[60:63] offset:9216
  ds_write_b128 v5, v[64:67] offset:16384
  ds_write_b128 v5, v[68:71] offset:17408
  ds_write_b128 v5, v[72:75] offset:24576
  ds_write_b128 v5, v[76:79] offset:25600
  s_waitcnt lgkmcnt(0)
  s_barrier
  ds_read_b128 v[16:19], v9 offset:0
  ds_read_b128 v[20:23], v9 offset:1024
  ds_read_b128 v[24:27], v9 offset:2048
  ds_read_b128 v[28:31], v9 offset:3072
  ds_read_b128 v[32:35], v9 offset:4096
  ds_read_b128 v[36:39], v9 offset:5120
  ds_read_b128 v[40:43], v9 offset:6144
  ds_read_b128 v[44:47], v9 offset:7168
  s_waitcnt lgkmcnt(4)
  v_pk_add_f32 v[16:17], v[16:17], v[24:25]
  v_pk_add_f32 v[18:19], v[18:19], v[26:27]
  v_pk_add_f32 v[20:21], v[20:21], v[28:29]
  v_pk_add_f32 v[22:23], v[22:23], v[30:31]
  s_waitcnt lgkmcnt(0)
  v_pk_add_f32 v[32:33], v[32:33], v[40:41]
  v_pk_add_f32 v[34:35], v[34:35], v[42:43]
  v_pk_add_f32 v[36:37], v[36:37], v[44:45]
  v_pk_add_f32 v[38:39], v[38:39], v[46:47]
  v_pk_add_f32 v[16:17], v[16:17], v[32:33]
  v_pk_add_f32 v[18:19], v[18:19], v[34:35]
  v_pk_add_f32 v[20:21], v[20:21], v[36:37]
  v_pk_add_f32 v[22:23], v[22:23], v[38:39]
  v_pk_fma_f32 v[16:17], v[16:17], v[116:117], v[80:81]
  v_pk_fma_f32 v[18:19], v[18:19], v[118:119], v[82:83]
  v_pk_fma_f32 v[20:21], v[20:21], v[120:121], v[84:85]
  v_pk_fma_f32 v[22:23], v[22:23], v[122:123], v[86:87]
  v_cvt_pk_bf16_f32 v80, v16, v17
  v_cvt_pk_bf16_f32 v81, v18, v19
  v_cvt_pk_bf16_f32 v82, v20, v21
  v_cvt_pk_bf16_f32 v83, v22, v23
  buffer_store_dwordx4 v[80:83], v4, s[8:11], 0 offen
ffn_kernel_end:
  s_endpgm
.section .rodata,"a"
.p2align 6
.amdhsa_kernel conv_kernel
  .amdhsa_next_free_vgpr 256
  .amdhsa_next_free_sgpr 102
  .amdhsa_accum_offset 256
  .amdhsa_group_segment_fixed_size 0
  .amdhsa_kernarg_size 120
  .amdhsa_user_sgpr_count 2
  .amdhsa_user_sgpr_kernarg_segment_ptr 1
  .amdhsa_system_sgpr_workgroup_id_x 1
  .amdhsa_float_denorm_mode_32 3
.end_amdhsa_kernel
.section .rodata,"a"
.p2align 6
.amdhsa_kernel ffn_kernel
  .amdhsa_next_free_vgpr 256
  .amdhsa_next_free_sgpr 102
  .amdhsa_accum_offset 128
  .amdhsa_group_segment_fixed_size 0
  .amdhsa_kernarg_size 120
  .amdhsa_user_sgpr_count 2
  .amdhsa_user_sgpr_kernarg_segment_ptr 1
  .amdhsa_system_sgpr_workgroup_id_x 1
  .amdhsa_float_denorm_mode_32 3
.end_amdhsa_kernel
```
